```python
import torch

def _softmax(x, axis=-1):
    return torch.softmax(x, dim=axis)
def _gelu(x):
    return torch.nn.functional.gelu(x, approximate="tanh")
def _silu(x):
    return torch.nn.functional.silu(x)
def _sigmoid(x):
    return torch.sigmoid(x)
def _layernorm(x, axis=-1, eps=1e-5):
    m = x.mean(dim=axis, keepdim=True)
    v = x.var(dim=axis, keepdim=True, unbiased=False)
    return (x - m) / torch.sqrt(v + eps)
def _scatter_add(tgt, idx, src, axis=0):
    return tgt.clone().index_add_(axis, idx, src)
def _segment_sum(src, seg, n):
    out = torch.zeros((n,) + src.shape[1:], dtype=src.dtype)
    return out.index_add_(0, seg, src)
def _pad(x, pw):
    flat = tuple(v for pair in reversed(pw) for v in pair)
    return torch.nn.functional.pad(x, flat)

kernel_name = 'standalone__mha_block_cached__near_ridge'

def setup_inputs():

    _w = (lambda a: (lambda t: t.to(torch.bfloat16) if t.is_floating_point() else t)(torch.as_tensor(a)))
    B, Sq, D = 32, 32, 576
    H, Sk, Dh = 32, 32, 128
    return {
        "x": _w((lambda *s: torch.randn(*s, dtype=torch.bfloat16) * 0.8)(B, Sq, D)),
        "k_cache": _w((lambda *s: torch.randn(*s, dtype=torch.bfloat16) * 0.8)(B, H, Sk, Dh)),
        "v_cache": _w((lambda *s: torch.randn(*s, dtype=torch.bfloat16) * 0.05)(B, H, Sk, Dh)),
        "wq": _w((lambda *s: torch.randn(*s, dtype=torch.bfloat16) * 0.8)(D, H * Dh) * (D ** -0.5)),
        "wo": _w((lambda *s: torch.randn(*s, dtype=torch.bfloat16) * 0.05)(H * Dh, D) * ((H * Dh) ** -0.5)),
    }

def reference(x, k_cache, v_cache, wq, wo):
    B, Sq, D = x.shape
    H, Dh = 32, 128
    q = (lambda x, *d: x.permute(*d))((x @ wq).reshape(B, Sq, H, Dh), 0, 2, 1, 3)
    scores = torch.einsum("bhqd,bhkd->bhqk", q, k_cache) * (Dh ** -0.5)
    p = _softmax(scores, axis=-1)
    o = torch.einsum("bhqk,bhkd->bhqd", p, v_cache)
    return (lambda x, *d: x.permute(*d))(o, 0, 2, 1, 3).reshape(B, Sq, H * Dh) @ wo
```

```asm
; @launch grid=(256,1,1) block=(512,1,1) lds=163840
.amdgcn_target "amdgcn-amd-amdhsa--gfx950"
.text
.globl standalone__mha_block_cached__near_ridge_kernel
.p2align 8
.type standalone__mha_block_cached__near_ridge_kernel,@function
standalone__mha_block_cached__near_ridge_kernel:
    s_cmp_ge_u32 s2, 256
    s_cbranch_scc1 L_end_1
    s_load_dwordx4 s[4:7], s[0:1], 0
    s_load_dwordx4 s[8:11], s[0:1], 16
    s_load_dwordx2 s[96:97], s[0:1], 32
    s_load_dwordx2 s[14:15], s[0:1], 56
    v_lshrrev_b32 v1, 6, v0
    v_and_b32 v2, 63, v0
    s_nop 0
    v_readfirstlane_b32 s16, v1
    s_and_b32 s13, s2, 7
    s_lshl_b32 s17, s13, 2
    s_lshr_b32 s18, s2, 3
    s_and_b32 s19, s18, 3
    s_add_u32 s17, s17, s19
    s_lshr_b32 s18, s18, 2
    s_and_b32 s12, s16, 3
    s_lshl_b32 s46, s18, 2
    s_add_u32 s46, s46, s12
    s_lshl_b32 s47, s46, 5
    s_add_u32 s47, s47, s17
    s_lshl_b32 s47, s47, 13
    s_lshl_b32 s48, s12, 12
    s_lshl_b32 s49, s12, 13
    s_cmp_ge_u32 s16, 4
    s_cbranch_scc1 L_loader_2
    s_setprio 2
    v_lshrrev_b32 v36, 5, v2
    v_bfe_u32 v37, v2, 2, 2
    v_bfe_u32 v11, v2, 4, 1
    v_lshlrev_b32 v38, 5, v11
    v_and_b32 v11, 1, v2
    v_lshlrev_b32 v11, 4, v11
    v_add_u32 v38, v38, v11
    v_bfe_u32 v11, v2, 1, 1
    v_lshlrev_b32 v11, 3, v11
    v_add_u32 v38, v38, v11
    v_xor_b32 v11, 0, v37
    v_lshlrev_b32 v11, 6, v11
    v_add_u32 v11, v11, v38
    v_lshlrev_b32 v12, 3, v36
    v_add_u32 v12, v12, v37
    v_lshlrev_b32 v12, 8, v12
    v_add_u32 v14, v11, v12
    v_add_u32 v18, 0x10000, v14
    v_xor_b32 v11, 1, v37
    v_lshlrev_b32 v11, 6, v11
    v_add_u32 v11, v11, v38
    v_lshlrev_b32 v12, 3, v36
    v_add_u32 v12, v12, v37
    v_lshlrev_b32 v12, 8, v12
    v_add_u32 v15, v11, v12
    v_add_u32 v19, 0x10000, v15
    v_xor_b32 v11, 2, v37
    v_lshlrev_b32 v11, 6, v11
    v_add_u32 v11, v11, v38
    v_lshlrev_b32 v12, 3, v36
    v_add_u32 v12, v12, v37
    v_lshlrev_b32 v12, 8, v12
    v_add_u32 v16, v11, v12
    v_add_u32 v20, 0x10000, v16
    v_xor_b32 v11, 3, v37
    v_lshlrev_b32 v11, 6, v11
    v_add_u32 v11, v11, v38
    v_lshlrev_b32 v12, 3, v36
    v_add_u32 v12, v12, v37
    v_lshlrev_b32 v12, 8, v12
    v_add_u32 v17, v11, v12
    v_add_u32 v21, 0x10000, v17
    v_and_b32 v11, 31, v2
    v_bfe_u32 v12, v2, 1, 3
    v_xor_b32 v12, v12, v36
    v_lshlrev_b32 v12, 4, v12
    v_lshlrev_b32 v11, 7, v11
    s_add_u32 s51, s48, 16384
    v_xor_b32 v13, 0, v12
    v_add_u32 v13, v13, v11
    v_add_u32 v22, s51, v13
    v_add_u32 v26, 0x10000, v22
    v_xor_b32 v13, 32, v12
    v_add_u32 v13, v13, v11
    v_add_u32 v23, s51, v13
    v_add_u32 v27, 0x10000, v23
    v_xor_b32 v13, 64, v12
    v_add_u32 v13, v13, v11
    v_add_u32 v24, s51, v13
    v_add_u32 v28, 0x10000, v24
    v_xor_b32 v13, 96, v12
    v_add_u32 v13, v13, v11
    v_add_u32 v25, s51, v13
    v_add_u32 v29, 0x10000, v25
    v_and_b32 v12, 15, v2
    v_xor_b32 v12, v12, v36
    v_lshlrev_b32 v35, 4, v12
    v_and_b32 v11, 31, v2
    v_lshlrev_b32 v11, 8, v11
    s_add_u32 s51, s49, 131072
    v_add_u32 v34, s51, v11
    v_mov_b32 v64, 0
    v_mov_b32 v65, 0
    v_mov_b32 v66, 0
    v_mov_b32 v67, 0
    v_mov_b32 v68, 0
    v_mov_b32 v69, 0
    v_mov_b32 v70, 0
    v_mov_b32 v71, 0
    v_mov_b32 v72, 0
    v_mov_b32 v73, 0
    v_mov_b32 v74, 0
    v_mov_b32 v75, 0
    v_mov_b32 v76, 0
    v_mov_b32 v77, 0
    v_mov_b32 v78, 0
    v_mov_b32 v79, 0
    v_mov_b32 v80, 0
    v_mov_b32 v81, 0
    v_mov_b32 v82, 0
    v_mov_b32 v83, 0
    v_mov_b32 v84, 0
    v_mov_b32 v85, 0
    v_mov_b32 v86, 0
    v_mov_b32 v87, 0
    v_mov_b32 v88, 0
    v_mov_b32 v89, 0
    v_mov_b32 v90, 0
    v_mov_b32 v91, 0
    v_mov_b32 v92, 0
    v_mov_b32 v93, 0
    v_mov_b32 v94, 0
    v_mov_b32 v95, 0
    v_mov_b32 v96, 0
    v_mov_b32 v97, 0
    v_mov_b32 v98, 0
    v_mov_b32 v99, 0
    v_mov_b32 v100, 0
    v_mov_b32 v101, 0
    v_mov_b32 v102, 0
    v_mov_b32 v103, 0
    v_mov_b32 v104, 0
    v_mov_b32 v105, 0
    v_mov_b32 v106, 0
    v_mov_b32 v107, 0
    v_mov_b32 v108, 0
    v_mov_b32 v109, 0
    v_mov_b32 v110, 0
    v_mov_b32 v111, 0
    v_mov_b32 v112, 0
    v_mov_b32 v113, 0
    v_mov_b32 v114, 0
    v_mov_b32 v115, 0
    v_mov_b32 v116, 0
    v_mov_b32 v117, 0
    v_mov_b32 v118, 0
    v_mov_b32 v119, 0
    v_mov_b32 v120, 0
    v_mov_b32 v121, 0
    v_mov_b32 v122, 0
    v_mov_b32 v123, 0
    v_mov_b32 v124, 0
    v_mov_b32 v125, 0
    v_mov_b32 v126, 0
    v_mov_b32 v127, 0
    s_load_dwordx2 s[72:73], s[0:1], 48
    v_and_b32 v11, 15, v2
    v_lshrrev_b32 v12, 4, v2
    v_lshrrev_b32 v13, 1, v11
    v_xor_b32 v13, v13, v12
    v_lshlrev_b32 v13, 4, v13
    v_lshlrev_b32 v11, 7, v11
    s_lshl_b32 s58, s12, 12
    s_add_u32 s58, s58, 81920
    v_add_u32 v11, s58, v11
    v_add_u32 v244, v11, v13
    v_xor_b32 v13, 64, v13
    v_add_u32 v245, v11, v13
    v_lshlrev_b32 v11, 3, v12
    v_bfe_u32 v13, v2, 2, 2
    v_add_u32 v11, v11, v13
    v_mul_u32_u24 v11, 320, v11
    v_and_b32 v13, 3, v2
    v_lshlrev_b32 v13, 3, v13
    v_add_u32 v11, v11, v13
    v_and_b32 v12, 1, v12
    v_lshlrev_b32 v12, 5, v12
    v_add_u32 v246, v11, v12
    v_xor_b32 v12, 32, v12
    v_add_u32 v247, v11, v12
    s_and_b32 s58, s19, 1
    s_cmp_eq_u32 s58, 1
    s_cbranch_scc0 L_ev_4
    v_add_u32 v11, 64, v246
    v_mov_b32 v246, v247
    v_mov_b32 v247, v11
L_ev_4:
    v_add_u32 v248, 40960, v246
    v_add_u32 v249, 40960, v247
    v_lshlrev_b32 v250, 4, v2
    s_add_u32 s58, s49, 131072
    v_add_u32 v250, s58, v250
    s_add_u32 s62, s19, s18
    s_and_b32 s62, s62, 3
    v_xor_b32 v11, 0, v35
    v_add_u32 v40, v11, v34
    v_xor_b32 v11, 32, v35
    v_add_u32 v41, v11, v34
    v_xor_b32 v11, 64, v35
    v_add_u32 v42, v11, v34
    v_xor_b32 v11, 96, v35
    v_add_u32 v43, v11, v34
    v_xor_b32 v11, 128, v35
    v_add_u32 v44, v11, v34
    v_xor_b32 v11, 160, v35
    v_add_u32 v45, v11, v34
    v_xor_b32 v11, 192, v35
    v_add_u32 v46, v11, v34
    v_xor_b32 v11, 224, v35
    v_add_u32 v47, v11, v34
    v_bfe_u32 v11, v2, 4, 1
    v_lshlrev_b32 v11, 10, v11
    v_and_b32 v12, 15, v2
    v_lshlrev_b32 v12, 4, v12
    v_add_u32 v11, v11, v12
    v_lshrrev_b32 v12, 5, v2
    v_lshlrev_b32 v12, 8, v12
    v_add_u32 v11, v11, v12
    s_lshl_b32 s51, s19, 11
    s_add_u32 s51, s51, s49
    s_add_u32 s51, s51, 131072
    v_add_u32 v252, s51, v11
    s_mov_b32 s52, 0x3e0293ee
    s_waitcnt lgkmcnt(0)
    s_barrier
    ds_read_b128 v[176:179], v22 offset:0
    ds_read_b64_tr_b16 v[128:129], v14 offset:0
    ds_read_b64_tr_b16 v[130:131], v14 offset:1024
    ds_read_b64_tr_b16 v[132:133], v15 offset:0
    ds_read_b64_tr_b16 v[134:135], v15 offset:1024
    ds_read_b64_tr_b16 v[136:137], v16 offset:0
    ds_read_b64_tr_b16 v[138:139], v16 offset:1024
    ds_read_b64_tr_b16 v[140:141], v17 offset:0
    ds_read_b64_tr_b16 v[142:143], v17 offset:1024
    ds_read_b128 v[180:183], v23 offset:0
    ds_read_b64_tr_b16 v[144:145], v14 offset:4096
    ds_read_b64_tr_b16 v[146:147], v14 offset:5120
    ds_read_b64_tr_b16 v[148:149], v15 offset:4096
    ds_read_b64_tr_b16 v[150:151], v15 offset:5120
    ds_read_b64_tr_b16 v[152:153], v16 offset:4096
    ds_read_b64_tr_b16 v[154:155], v16 offset:5120
    ds_read_b64_tr_b16 v[156:157], v17 offset:4096
    ds_read_b64_tr_b16 v[158:159], v17 offset:5120
    s_waitcnt lgkmcnt(9)
    v_mfma_f32_32x32x16_bf16 v[64:79], v[128:131], v[176:179], v[64:79]
    ds_read_b128 v[184:187], v24 offset:0
    ds_read_b64_tr_b16 v[160:161], v14 offset:8192
    ds_read_b64_tr_b16 v[162:163], v14 offset:9216
    v_mfma_f32_32x32x16_bf16 v[80:95], v[132:135], v[176:179], v[80:95]
    ds_read_b64_tr_b16 v[164:165], v15 offset:8192
    ds_read_b64_tr_b16 v[166:167], v15 offset:9216
    ds_read_b64_tr_b16 v[168:169], v16 offset:8192
    v_mfma_f32_32x32x16_bf16 v[96:111], v[136:139], v[176:179], v[96:111]
    ds_read_b64_tr_b16 v[170:171], v16 offset:9216
    ds_read_b64_tr_b16 v[172:173], v17 offset:8192
    ds_read_b64_tr_b16 v[174:175], v17 offset:9216
    v_mfma_f32_32x32x16_bf16 v[112:127], v[140:143], v[176:179], v[112:127]
    s_waitcnt lgkmcnt(9)
    v_mfma_f32_32x32x16_bf16 v[64:79], v[144:147], v[180:183], v[64:79]
    ds_read_b128 v[176:179], v25 offset:0
    ds_read_b64_tr_b16 v[128:129], v14 offset:12288
    ds_read_b64_tr_b16 v[130:131], v14 offset:13312
    v_mfma_f32_32x32x16_bf16 v[80:95], v[148:151], v[180:183], v[80:95]
    ds_read_b64_tr_b16 v[132:133], v15 offset:12288
    ds_read_b64_tr_b16 v[134:135], v15 offset:13312
    ds_read_b64_tr_b16 v[136:137], v16 offset:12288
    v_mfma_f32_32x32x16_bf16 v[96:111], v[152:155], v[180:183], v[96:111]
    ds_read_b64_tr_b16 v[138:139], v16 offset:13312
    ds_read_b64_tr_b16 v[140:141], v17 offset:12288
    ds_read_b64_tr_b16 v[142:143], v17 offset:13312
    v_mfma_f32_32x32x16_bf16 v[112:127], v[156:159], v[180:183], v[112:127]
    s_barrier
    s_waitcnt lgkmcnt(9)
    v_mfma_f32_32x32x16_bf16 v[64:79], v[160:163], v[184:187], v[64:79]
    ds_read_b128 v[180:183], v22 offset:32768
    ds_read_b64_tr_b16 v[144:145], v14 offset:32768
    ds_read_b64_tr_b16 v[146:147], v14 offset:33792
    v_mfma_f32_32x32x16_bf16 v[80:95], v[164:167], v[184:187], v[80:95]
    ds_read_b64_tr_b16 v[148:149], v15 offset:32768
    ds_read_b64_tr_b16 v[150:151], v15 offset:33792
    ds_read_b64_tr_b16 v[152:153], v16 offset:32768
    v_mfma_f32_32x32x16_bf16 v[96:111], v[168:171], v[184:187], v[96:111]
    ds_read_b64_tr_b16 v[154:155], v16 offset:33792
    ds_read_b64_tr_b16 v[156:157], v17 offset:32768
    ds_read_b64_tr_b16 v[158:159], v17 offset:33792
    v_mfma_f32_32x32x16_bf16 v[112:127], v[172:175], v[184:187], v[112:127]
    s_waitcnt lgkmcnt(9)
    v_mfma_f32_32x32x16_bf16 v[64:79], v[128:131], v[176:179], v[64:79]
    ds_read_b128 v[184:187], v23 offset:32768
    ds_read_b64_tr_b16 v[160:161], v14 offset:36864
    ds_read_b64_tr_b16 v[162:163], v14 offset:37888
    v_mfma_f32_32x32x16_bf16 v[80:95], v[132:135], v[176:179], v[80:95]
    ds_read_b64_tr_b16 v[164:165], v15 offset:36864
    ds_read_b64_tr_b16 v[166:167], v15 offset:37888
    ds_read_b64_tr_b16 v[168:169], v16 offset:36864
    v_mfma_f32_32x32x16_bf16 v[96:111], v[136:139], v[176:179], v[96:111]
    ds_read_b64_tr_b16 v[170:171], v16 offset:37888
    ds_read_b64_tr_b16 v[172:173], v17 offset:36864
    ds_read_b64_tr_b16 v[174:175], v17 offset:37888
    v_mfma_f32_32x32x16_bf16 v[112:127], v[140:143], v[176:179], v[112:127]
    s_waitcnt lgkmcnt(9)
    v_mfma_f32_32x32x16_bf16 v[64:79], v[144:147], v[180:183], v[64:79]
    ds_read_b128 v[176:179], v24 offset:32768
    ds_read_b64_tr_b16 v[128:129], v14 offset:40960
    ds_read_b64_tr_b16 v[130:131], v14 offset:41984
    v_mfma_f32_32x32x16_bf16 v[80:95], v[148:151], v[180:183], v[80:95]
    ds_read_b64_tr_b16 v[132:133], v15 offset:40960
    ds_read_b64_tr_b16 v[134:135], v15 offset:41984
    ds_read_b64_tr_b16 v[136:137], v16 offset:40960
    v_mfma_f32_32x32x16_bf16 v[96:111], v[152:155], v[180:183], v[96:111]
    ds_read_b64_tr_b16 v[138:139], v16 offset:41984
    ds_read_b64_tr_b16 v[140:141], v17 offset:40960
    ds_read_b64_tr_b16 v[142:143], v17 offset:41984
    v_mfma_f32_32x32x16_bf16 v[112:127], v[156:159], v[180:183], v[112:127]
    s_waitcnt lgkmcnt(9)
    v_mfma_f32_32x32x16_bf16 v[64:79], v[160:163], v[184:187], v[64:79]
    ds_read_b128 v[180:183], v25 offset:32768
    ds_read_b64_tr_b16 v[144:145], v14 offset:45056
    ds_read_b64_tr_b16 v[146:147], v14 offset:46080
    v_mfma_f32_32x32x16_bf16 v[80:95], v[164:167], v[184:187], v[80:95]
    ds_read_b64_tr_b16 v[148:149], v15 offset:45056
    ds_read_b64_tr_b16 v[150:151], v15 offset:46080
    ds_read_b64_tr_b16 v[152:153], v16 offset:45056
    v_mfma_f32_32x32x16_bf16 v[96:111], v[168:171], v[184:187], v[96:111]
    ds_read_b64_tr_b16 v[154:155], v16 offset:46080
    ds_read_b64_tr_b16 v[156:157], v17 offset:45056
    ds_read_b64_tr_b16 v[158:159], v17 offset:46080
    v_mfma_f32_32x32x16_bf16 v[112:127], v[172:175], v[184:187], v[112:127]
    s_barrier
    s_waitcnt lgkmcnt(9)
    v_mfma_f32_32x32x16_bf16 v[64:79], v[128:131], v[176:179], v[64:79]
    ds_read_b128 v[184:187], v26 offset:0
    ds_read_b64_tr_b16 v[160:161], v18 offset:0
    ds_read_b64_tr_b16 v[162:163], v18 offset:1024
    v_mfma_f32_32x32x16_bf16 v[80:95], v[132:135], v[176:179], v[80:95]
    ds_read_b64_tr_b16 v[164:165], v19 offset:0
    ds_read_b64_tr_b16 v[166:167], v19 offset:1024
    ds_read_b64_tr_b16 v[168:169], v20 offset:0
    v_mfma_f32_32x32x16_bf16 v[96:111], v[136:139], v[176:179], v[96:111]
    ds_read_b64_tr_b16 v[170:171], v20 offset:1024
    ds_read_b64_tr_b16 v[172:173], v21 offset:0
    ds_read_b64_tr_b16 v[174:175], v21 offset:1024
    v_mfma_f32_32x32x16_bf16 v[112:127], v[140:143], v[176:179], v[112:127]
    s_waitcnt lgkmcnt(9)
    v_mfma_f32_32x32x16_bf16 v[64:79], v[144:147], v[180:183], v[64:79]
    ds_read_b128 v[176:179], v27 offset:0
    ds_read_b64_tr_b16 v[128:129], v18 offset:4096
    ds_read_b64_tr_b16 v[130:131], v18 offset:5120
    v_mfma_f32_32x32x16_bf16 v[80:95], v[148:151], v[180:183], v[80:95]
    ds_read_b64_tr_b16 v[132:133], v19 offset:4096
    ds_read_b64_tr_b16 v[134:135], v19 offset:5120
    ds_read_b64_tr_b16 v[136:137], v20 offset:4096
    v_mfma_f32_32x32x16_bf16 v[96:111], v[152:155], v[180:183], v[96:111]
    ds_read_b64_tr_b16 v[138:139], v20 offset:5120
    ds_read_b64_tr_b16 v[140:141], v21 offset:4096
    ds_read_b64_tr_b16 v[142:143], v21 offset:5120
    v_mfma_f32_32x32x16_bf16 v[112:127], v[156:159], v[180:183], v[112:127]
    s_waitcnt lgkmcnt(9)
    v_mfma_f32_32x32x16_bf16 v[64:79], v[160:163], v[184:187], v[64:79]
    ds_read_b128 v[180:183], v28 offset:0
    ds_read_b64_tr_b16 v[144:145], v18 offset:8192
    ds_read_b64_tr_b16 v[146:147], v18 offset:9216
    v_mfma_f32_32x32x16_bf16 v[80:95], v[164:167], v[184:187], v[80:95]
    ds_read_b64_tr_b16 v[148:149], v19 offset:8192
    ds_read_b64_tr_b16 v[150:151], v19 offset:9216
    ds_read_b64_tr_b16 v[152:153], v20 offset:8192
    v_mfma_f32_32x32x16_bf16 v[96:111], v[168:171], v[184:187], v[96:111]
    ds_read_b64_tr_b16 v[154:155], v20 offset:9216
    ds_read_b64_tr_b16 v[156:157], v21 offset:8192
    ds_read_b64_tr_b16 v[158:159], v21 offset:9216
    v_mfma_f32_32x32x16_bf16 v[112:127], v[172:175], v[184:187], v[112:127]
    s_waitcnt lgkmcnt(9)
    v_mfma_f32_32x32x16_bf16 v[64:79], v[128:131], v[176:179], v[64:79]
    ds_read_b128 v[184:187], v29 offset:0
    ds_read_b64_tr_b16 v[160:161], v18 offset:12288
    ds_read_b64_tr_b16 v[162:163], v18 offset:13312
    v_mfma_f32_32x32x16_bf16 v[80:95], v[132:135], v[176:179], v[80:95]
    ds_read_b64_tr_b16 v[164:165], v19 offset:12288
    ds_read_b64_tr_b16 v[166:167], v19 offset:13312
    ds_read_b64_tr_b16 v[168:169], v20 offset:12288
    v_mfma_f32_32x32x16_bf16 v[96:111], v[136:139], v[176:179], v[96:111]
    ds_read_b64_tr_b16 v[170:171], v20 offset:13312
    ds_read_b64_tr_b16 v[172:173], v21 offset:12288
    ds_read_b64_tr_b16 v[174:175], v21 offset:13312
    v_mfma_f32_32x32x16_bf16 v[112:127], v[140:143], v[176:179], v[112:127]
    s_barrier
    s_waitcnt lgkmcnt(9)
    v_mfma_f32_32x32x16_bf16 v[64:79], v[144:147], v[180:183], v[64:79]
    ds_read_b128 v[176:179], v26 offset:32768
    ds_read_b64_tr_b16 v[128:129], v18 offset:32768
    ds_read_b64_tr_b16 v[130:131], v18 offset:33792
    v_mfma_f32_32x32x16_bf16 v[80:95], v[148:151], v[180:183], v[80:95]
    ds_read_b64_tr_b16 v[132:133], v19 offset:32768
    ds_read_b64_tr_b16 v[134:135], v19 offset:33792
    ds_read_b64_tr_b16 v[136:137], v20 offset:32768
    v_mfma_f32_32x32x16_bf16 v[96:111], v[152:155], v[180:183], v[96:111]
    ds_read_b64_tr_b16 v[138:139], v20 offset:33792
    ds_read_b64_tr_b16 v[140:141], v21 offset:32768
    ds_read_b64_tr_b16 v[142:143], v21 offset:33792
    v_mfma_f32_32x32x16_bf16 v[112:127], v[156:159], v[180:183], v[112:127]
    s_waitcnt lgkmcnt(9)
    v_mfma_f32_32x32x16_bf16 v[64:79], v[160:163], v[184:187], v[64:79]
    ds_read_b128 v[180:183], v27 offset:32768
    ds_read_b64_tr_b16 v[144:145], v18 offset:36864
    ds_read_b64_tr_b16 v[146:147], v18 offset:37888
    v_mfma_f32_32x32x16_bf16 v[80:95], v[164:167], v[184:187], v[80:95]
    ds_read_b64_tr_b16 v[148:149], v19 offset:36864
    ds_read_b64_tr_b16 v[150:151], v19 offset:37888
    ds_read_b64_tr_b16 v[152:153], v20 offset:36864
    v_mfma_f32_32x32x16_bf16 v[96:111], v[168:171], v[184:187], v[96:111]
    ds_read_b64_tr_b16 v[154:155], v20 offset:37888
    ds_read_b64_tr_b16 v[156:157], v21 offset:36864
    ds_read_b64_tr_b16 v[158:159], v21 offset:37888
    v_mfma_f32_32x32x16_bf16 v[112:127], v[172:175], v[184:187], v[112:127]
    s_waitcnt lgkmcnt(9)
    v_mfma_f32_32x32x16_bf16 v[64:79], v[128:131], v[176:179], v[64:79]
    ds_read_b128 v[184:187], v28 offset:32768
    ds_read_b64_tr_b16 v[160:161], v18 offset:40960
    ds_read_b64_tr_b16 v[162:163], v18 offset:41984
    v_mfma_f32_32x32x16_bf16 v[80:95], v[132:135], v[176:179], v[80:95]
    ds_read_b64_tr_b16 v[164:165], v19 offset:40960
    ds_read_b64_tr_b16 v[166:167], v19 offset:41984
    ds_read_b64_tr_b16 v[168:169], v20 offset:40960
    v_mfma_f32_32x32x16_bf16 v[96:111], v[136:139], v[176:179], v[96:111]
    ds_read_b64_tr_b16 v[170:171], v20 offset:41984
    ds_read_b64_tr_b16 v[172:173], v21 offset:40960
    ds_read_b64_tr_b16 v[174:175], v21 offset:41984
    v_mfma_f32_32x32x16_bf16 v[112:127], v[140:143], v[176:179], v[112:127]
    s_waitcnt lgkmcnt(9)
    v_mfma_f32_32x32x16_bf16 v[64:79], v[144:147], v[180:183], v[64:79]
    ds_read_b128 v[176:179], v29 offset:32768
    ds_read_b64_tr_b16 v[128:129], v18 offset:45056
    ds_read_b64_tr_b16 v[130:131], v18 offset:46080
    v_mfma_f32_32x32x16_bf16 v[80:95], v[148:151], v[180:183], v[80:95]
    ds_read_b64_tr_b16 v[132:133], v19 offset:45056
    ds_read_b64_tr_b16 v[134:135], v19 offset:46080
    ds_read_b64_tr_b16 v[136:137], v20 offset:45056
    v_mfma_f32_32x32x16_bf16 v[96:111], v[152:155], v[180:183], v[96:111]
    ds_read_b64_tr_b16 v[138:139], v20 offset:46080
    ds_read_b64_tr_b16 v[140:141], v21 offset:45056
    ds_read_b64_tr_b16 v[142:143], v21 offset:46080
    v_mfma_f32_32x32x16_bf16 v[112:127], v[156:159], v[180:183], v[112:127]
    s_barrier
    s_waitcnt lgkmcnt(9)
    v_mfma_f32_32x32x16_bf16 v[64:79], v[160:163], v[184:187], v[64:79]
    ds_read_b128 v[180:183], v22 offset:0
    ds_read_b64_tr_b16 v[144:145], v14 offset:0
    ds_read_b64_tr_b16 v[146:147], v14 offset:1024
    v_mfma_f32_32x32x16_bf16 v[80:95], v[164:167], v[184:187], v[80:95]
    ds_read_b64_tr_b16 v[148:149], v15 offset:0
    ds_read_b64_tr_b16 v[150:151], v15 offset:1024
    ds_read_b64_tr_b16 v[152:153], v16 offset:0
    v_mfma_f32_32x32x16_bf16 v[96:111], v[168:171], v[184:187], v[96:111]
    ds_read_b64_tr_b16 v[154:155], v16 offset:1024
    ds_read_b64_tr_b16 v[156:157], v17 offset:0
    ds_read_b64_tr_b16 v[158:159], v17 offset:1024
    v_mfma_f32_32x32x16_bf16 v[112:127], v[172:175], v[184:187], v[112:127]
    s_waitcnt lgkmcnt(9)
    v_mfma_f32_32x32x16_bf16 v[64:79], v[128:131], v[176:179], v[64:79]
    ds_read_b128 v[184:187], v23 offset:0
    ds_read_b64_tr_b16 v[160:161], v14 offset:4096
    ds_read_b64_tr_b16 v[162:163], v14 offset:5120
    v_mfma_f32_32x32x16_bf16 v[80:95], v[132:135], v[176:179], v[80:95]
    ds_read_b64_tr_b16 v[164:165], v15 offset:4096
    ds_read_b64_tr_b16 v[166:167], v15 offset:5120
    ds_read_b64_tr_b16 v[168:169], v16 offset:4096
    v_mfma_f32_32x32x16_bf16 v[96:111], v[136:139], v[176:179], v[96:111]
    ds_read_b64_tr_b16 v[170:171], v16 offset:5120
    ds_read_b64_tr_b16 v[172:173], v17 offset:4096
    ds_read_b64_tr_b16 v[174:175], v17 offset:5120
    v_mfma_f32_32x32x16_bf16 v[112:127], v[140:143], v[176:179], v[112:127]
    s_waitcnt lgkmcnt(9)
    v_mfma_f32_32x32x16_bf16 v[64:79], v[144:147], v[180:183], v[64:79]
    ds_read_b128 v[176:179], v24 offset:0
    ds_read_b64_tr_b16 v[128:129], v14 offset:8192
    ds_read_b64_tr_b16 v[130:131], v14 offset:9216
    v_mfma_f32_32x32x16_bf16 v[80:95], v[148:151], v[180:183], v[80:95]
    ds_read_b64_tr_b16 v[132:133], v15 offset:8192
    ds_read_b64_tr_b16 v[134:135], v15 offset:9216
    ds_read_b64_tr_b16 v[136:137], v16 offset:8192
    v_mfma_f32_32x32x16_bf16 v[96:111], v[152:155], v[180:183], v[96:111]
    ds_read_b64_tr_b16 v[138:139], v16 offset:9216
    ds_read_b64_tr_b16 v[140:141], v17 offset:8192
    ds_read_b64_tr_b16 v[142:143], v17 offset:9216
    v_mfma_f32_32x32x16_bf16 v[112:127], v[156:159], v[180:183], v[112:127]
    s_waitcnt lgkmcnt(9)
    v_mfma_f32_32x32x16_bf16 v[64:79], v[160:163], v[184:187], v[64:79]
    ds_read_b128 v[180:183], v25 offset:0
    ds_read_b64_tr_b16 v[144:145], v14 offset:12288
    ds_read_b64_tr_b16 v[146:147], v14 offset:13312
    v_mfma_f32_32x32x16_bf16 v[80:95], v[164:167], v[184:187], v[80:95]
    ds_read_b64_tr_b16 v[148:149], v15 offset:12288
    ds_read_b64_tr_b16 v[150:151], v15 offset:13312
    ds_read_b64_tr_b16 v[152:153], v16 offset:12288
    v_mfma_f32_32x32x16_bf16 v[96:111], v[168:171], v[184:187], v[96:111]
    ds_read_b64_tr_b16 v[154:155], v16 offset:13312
    ds_read_b64_tr_b16 v[156:157], v17 offset:12288
    ds_read_b64_tr_b16 v[158:159], v17 offset:13312
    v_mfma_f32_32x32x16_bf16 v[112:127], v[172:175], v[184:187], v[112:127]
    s_barrier
    s_waitcnt lgkmcnt(9)
    v_mfma_f32_32x32x16_bf16 v[64:79], v[128:131], v[176:179], v[64:79]
    ds_read_b128 v[184:187], v22 offset:32768
    ds_read_b64_tr_b16 v[160:161], v14 offset:32768
    ds_read_b64_tr_b16 v[162:163], v14 offset:33792
    v_mfma_f32_32x32x16_bf16 v[80:95], v[132:135], v[176:179], v[80:95]
    ds_read_b64_tr_b16 v[164:165], v15 offset:32768
    ds_read_b64_tr_b16 v[166:167], v15 offset:33792
    ds_read_b64_tr_b16 v[168:169], v16 offset:32768
    v_mfma_f32_32x32x16_bf16 v[96:111], v[136:139], v[176:179], v[96:111]
    ds_read_b64_tr_b16 v[170:171], v16 offset:33792
    ds_read_b64_tr_b16 v[172:173], v17 offset:32768
    ds_read_b64_tr_b16 v[174:175], v17 offset:33792
    v_mfma_f32_32x32x16_bf16 v[112:127], v[140:143], v[176:179], v[112:127]
    s_waitcnt lgkmcnt(9)
    v_mfma_f32_32x32x16_bf16 v[64:79], v[144:147], v[180:183], v[64:79]
    ds_read_b128 v[176:179], v23 offset:32768
    ds_read_b64_tr_b16 v[128:129], v14 offset:36864
    ds_read_b64_tr_b16 v[130:131], v14 offset:37888
    v_mfma_f32_32x32x16_bf16 v[80:95], v[148:151], v[180:183], v[80:95]
    ds_read_b64_tr_b16 v[132:133], v15 offset:36864
    ds_read_b64_tr_b16 v[134:135], v15 offset:37888
    ds_read_b64_tr_b16 v[136:137], v16 offset:36864
    v_mfma_f32_32x32x16_bf16 v[96:111], v[152:155], v[180:183], v[96:111]
    ds_read_b64_tr_b16 v[138:139], v16 offset:37888
    ds_read_b64_tr_b16 v[140:141], v17 offset:36864
    ds_read_b64_tr_b16 v[142:143], v17 offset:37888
    v_mfma_f32_32x32x16_bf16 v[112:127], v[156:159], v[180:183], v[112:127]
    s_waitcnt lgkmcnt(9)
    v_mfma_f32_32x32x16_bf16 v[64:79], v[160:163], v[184:187], v[64:79]
    ds_read_b128 v[180:183], v24 offset:32768
    ds_read_b64_tr_b16 v[144:145], v14 offset:40960
    ds_read_b64_tr_b16 v[146:147], v14 offset:41984
    v_mfma_f32_32x32x16_bf16 v[80:95], v[164:167], v[184:187], v[80:95]
    ds_read_b64_tr_b16 v[148:149], v15 offset:40960
    ds_read_b64_tr_b16 v[150:151], v15 offset:41984
    ds_read_b64_tr_b16 v[152:153], v16 offset:40960
    v_mfma_f32_32x32x16_bf16 v[96:111], v[168:171], v[184:187], v[96:111]
    ds_read_b64_tr_b16 v[154:155], v16 offset:41984
    ds_read_b64_tr_b16 v[156:157], v17 offset:40960
    ds_read_b64_tr_b16 v[158:159], v17 offset:41984
    v_mfma_f32_32x32x16_bf16 v[112:127], v[172:175], v[184:187], v[112:127]
    s_waitcnt lgkmcnt(9)
    v_mfma_f32_32x32x16_bf16 v[64:79], v[128:131], v[176:179], v[64:79]
    ds_read_b128 v[184:187], v25 offset:32768
    ds_read_b64_tr_b16 v[160:161], v14 offset:45056
    ds_read_b64_tr_b16 v[162:163], v14 offset:46080
    v_mfma_f32_32x32x16_bf16 v[80:95], v[132:135], v[176:179], v[80:95]
    ds_read_b64_tr_b16 v[164:165], v15 offset:45056
    ds_read_b64_tr_b16 v[166:167], v15 offset:46080
    ds_read_b64_tr_b16 v[168:169], v16 offset:45056
    v_mfma_f32_32x32x16_bf16 v[96:111], v[136:139], v[176:179], v[96:111]
    ds_read_b64_tr_b16 v[170:171], v16 offset:46080
    ds_read_b64_tr_b16 v[172:173], v17 offset:45056
    ds_read_b64_tr_b16 v[174:175], v17 offset:46080
    v_mfma_f32_32x32x16_bf16 v[112:127], v[140:143], v[176:179], v[112:127]
    s_barrier
    s_waitcnt lgkmcnt(9)
    v_mfma_f32_32x32x16_bf16 v[64:79], v[144:147], v[180:183], v[64:79]
    ds_read_b128 v[176:179], v26 offset:0
    ds_read_b64_tr_b16 v[128:129], v18 offset:0
    ds_read_b64_tr_b16 v[130:131], v18 offset:1024
    v_mfma_f32_32x32x16_bf16 v[80:95], v[148:151], v[180:183], v[80:95]
    ds_read_b64_tr_b16 v[132:133], v19 offset:0
    ds_read_b64_tr_b16 v[134:135], v19 offset:1024
    ds_read_b64_tr_b16 v[136:137], v20 offset:0
    v_mfma_f32_32x32x16_bf16 v[96:111], v[152:155], v[180:183], v[96:111]
    ds_read_b64_tr_b16 v[138:139], v20 offset:1024
    ds_read_b64_tr_b16 v[140:141], v21 offset:0
    ds_read_b64_tr_b16 v[142:143], v21 offset:1024
    v_mfma_f32_32x32x16_bf16 v[112:127], v[156:159], v[180:183], v[112:127]
    s_waitcnt lgkmcnt(9)
    v_mfma_f32_32x32x16_bf16 v[64:79], v[160:163], v[184:187], v[64:79]
    ds_read_b128 v[180:183], v27 offset:0
    ds_read_b64_tr_b16 v[144:145], v18 offset:4096
    ds_read_b64_tr_b16 v[146:147], v18 offset:5120
    v_mfma_f32_32x32x16_bf16 v[80:95], v[164:167], v[184:187], v[80:95]
    ds_read_b64_tr_b16 v[148:149], v19 offset:4096
    ds_read_b64_tr_b16 v[150:151], v19 offset:5120
    ds_read_b64_tr_b16 v[152:153], v20 offset:4096
    v_mfma_f32_32x32x16_bf16 v[96:111], v[168:171], v[184:187], v[96:111]
    ds_read_b64_tr_b16 v[154:155], v20 offset:5120
    ds_read_b64_tr_b16 v[156:157], v21 offset:4096
    ds_read_b64_tr_b16 v[158:159], v21 offset:5120
    v_mfma_f32_32x32x16_bf16 v[112:127], v[172:175], v[184:187], v[112:127]
    s_waitcnt lgkmcnt(9)
    v_mfma_f32_32x32x16_bf16 v[64:79], v[128:131], v[176:179], v[64:79]
    ds_read_b128 v[184:187], v28 offset:0
    ds_read_b64_tr_b16 v[160:161], v18 offset:8192
    ds_read_b64_tr_b16 v[162:163], v18 offset:9216
    v_mfma_f32_32x32x16_bf16 v[80:95], v[132:135], v[176:179], v[80:95]
    ds_read_b64_tr_b16 v[164:165], v19 offset:8192
    ds_read_b64_tr_b16 v[166:167], v19 offset:9216
    ds_read_b64_tr_b16 v[168:169], v20 offset:8192
    v_mfma_f32_32x32x16_bf16 v[96:111], v[136:139], v[176:179], v[96:111]
    ds_read_b64_tr_b16 v[170:171], v20 offset:9216
    ds_read_b64_tr_b16 v[172:173], v21 offset:8192
    ds_read_b64_tr_b16 v[174:175], v21 offset:9216
    v_mfma_f32_32x32x16_bf16 v[112:127], v[140:143], v[176:179], v[112:127]
    s_waitcnt lgkmcnt(9)
    v_mfma_f32_32x32x16_bf16 v[64:79], v[144:147], v[180:183], v[64:79]
    ds_read_b128 v[176:179], v29 offset:0
    ds_read_b64_tr_b16 v[128:129], v18 offset:12288
    ds_read_b64_tr_b16 v[130:131], v18 offset:13312
    v_mfma_f32_32x32x16_bf16 v[80:95], v[148:151], v[180:183], v[80:95]
    ds_read_b64_tr_b16 v[132:133], v19 offset:12288
    ds_read_b64_tr_b16 v[134:135], v19 offset:13312
    ds_read_b64_tr_b16 v[136:137], v20 offset:12288
    v_mfma_f32_32x32x16_bf16 v[96:111], v[152:155], v[180:183], v[96:111]
    ds_read_b64_tr_b16 v[138:139], v20 offset:13312
    ds_read_b64_tr_b16 v[140:141], v21 offset:12288
    ds_read_b64_tr_b16 v[142:143], v21 offset:13312
    v_mfma_f32_32x32x16_bf16 v[112:127], v[156:159], v[180:183], v[112:127]
    s_barrier
    s_waitcnt lgkmcnt(9)
    v_mfma_f32_32x32x16_bf16 v[64:79], v[160:163], v[184:187], v[64:79]
    ds_read_b128 v[180:183], v26 offset:32768
    ds_read_b64_tr_b16 v[144:145], v18 offset:32768
    ds_read_b64_tr_b16 v[146:147], v18 offset:33792
    v_mfma_f32_32x32x16_bf16 v[80:95], v[164:167], v[184:187], v[80:95]
    ds_read_b64_tr_b16 v[148:149], v19 offset:32768
    ds_read_b64_tr_b16 v[150:151], v19 offset:33792
    ds_read_b64_tr_b16 v[152:153], v20 offset:32768
    v_mfma_f32_32x32x16_bf16 v[96:111], v[168:171], v[184:187], v[96:111]
    ds_read_b64_tr_b16 v[154:155], v20 offset:33792
    ds_read_b64_tr_b16 v[156:157], v21 offset:32768
    ds_read_b64_tr_b16 v[158:159], v21 offset:33792
    v_mfma_f32_32x32x16_bf16 v[112:127], v[172:175], v[184:187], v[112:127]
    s_waitcnt lgkmcnt(9)
    v_mfma_f32_32x32x16_bf16 v[64:79], v[128:131], v[176:179], v[64:79]
    ds_read_b128 v[184:187], v27 offset:32768
    ds_read_b64_tr_b16 v[160:161], v18 offset:36864
    ds_read_b64_tr_b16 v[162:163], v18 offset:37888
    v_mfma_f32_32x32x16_bf16 v[80:95], v[132:135], v[176:179], v[80:95]
    ds_read_b64_tr_b16 v[164:165], v19 offset:36864
    ds_read_b64_tr_b16 v[166:167], v19 offset:37888
    ds_read_b64_tr_b16 v[168:169], v20 offset:36864
    v_mfma_f32_32x32x16_bf16 v[96:111], v[136:139], v[176:179], v[96:111]
    ds_read_b64_tr_b16 v[170:171], v20 offset:37888
    ds_read_b64_tr_b16 v[172:173], v21 offset:36864
    ds_read_b64_tr_b16 v[174:175], v21 offset:37888
    v_mfma_f32_32x32x16_bf16 v[112:127], v[140:143], v[176:179], v[112:127]
    s_waitcnt lgkmcnt(9)
    v_mfma_f32_32x32x16_bf16 v[64:79], v[144:147], v[180:183], v[64:79]
    ds_read_b128 v[176:179], v28 offset:32768
    ds_read_b64_tr_b16 v[128:129], v18 offset:40960
    ds_read_b64_tr_b16 v[130:131], v18 offset:41984
    v_mfma_f32_32x32x16_bf16 v[80:95], v[148:151], v[180:183], v[80:95]
    ds_read_b64_tr_b16 v[132:133], v19 offset:40960
    ds_read_b64_tr_b16 v[134:135], v19 offset:41984
    ds_read_b64_tr_b16 v[136:137], v20 offset:40960
    v_mfma_f32_32x32x16_bf16 v[96:111], v[152:155], v[180:183], v[96:111]
    ds_read_b64_tr_b16 v[138:139], v20 offset:41984
    ds_read_b64_tr_b16 v[140:141], v21 offset:40960
    ds_read_b64_tr_b16 v[142:143], v21 offset:41984
    v_mfma_f32_32x32x16_bf16 v[112:127], v[156:159], v[180:183], v[112:127]
    s_waitcnt lgkmcnt(9)
    v_mfma_f32_32x32x16_bf16 v[64:79], v[160:163], v[184:187], v[64:79]
    ds_read_b128 v[180:183], v29 offset:32768
    ds_read_b64_tr_b16 v[144:145], v18 offset:45056
    ds_read_b64_tr_b16 v[146:147], v18 offset:46080
    v_mfma_f32_32x32x16_bf16 v[80:95], v[164:167], v[184:187], v[80:95]
    ds_read_b64_tr_b16 v[148:149], v19 offset:45056
    ds_read_b64_tr_b16 v[150:151], v19 offset:46080
    ds_read_b64_tr_b16 v[152:153], v20 offset:45056
    v_mfma_f32_32x32x16_bf16 v[96:111], v[168:171], v[184:187], v[96:111]
    ds_read_b64_tr_b16 v[154:155], v20 offset:46080
    ds_read_b64_tr_b16 v[156:157], v21 offset:45056
    ds_read_b64_tr_b16 v[158:159], v21 offset:46080
    v_mfma_f32_32x32x16_bf16 v[112:127], v[172:175], v[184:187], v[112:127]
    s_barrier
    s_waitcnt lgkmcnt(9)
    v_mfma_f32_32x32x16_bf16 v[64:79], v[128:131], v[176:179], v[64:79]
    ds_read_b128 v[184:187], v22 offset:0
    ds_read_b64_tr_b16 v[160:161], v14 offset:0
    ds_read_b64_tr_b16 v[162:163], v14 offset:1024
    v_mfma_f32_32x32x16_bf16 v[80:95], v[132:135], v[176:179], v[80:95]
    ds_read_b64_tr_b16 v[164:165], v15 offset:0
    ds_read_b64_tr_b16 v[166:167], v15 offset:1024
    ds_read_b64_tr_b16 v[168:169], v16 offset:0
    v_mfma_f32_32x32x16_bf16 v[96:111], v[136:139], v[176:179], v[96:111]
    ds_read_b64_tr_b16 v[170:171], v16 offset:1024
    ds_read_b64_tr_b16 v[172:173], v17 offset:0
    ds_read_b64_tr_b16 v[174:175], v17 offset:1024
    v_mfma_f32_32x32x16_bf16 v[112:127], v[140:143], v[176:179], v[112:127]
    s_waitcnt lgkmcnt(9)
    v_mfma_f32_32x32x16_bf16 v[64:79], v[144:147], v[180:183], v[64:79]
    ds_read_b128 v[176:179], v23 offset:0
    ds_read_b64_tr_b16 v[128:129], v14 offset:4096
    ds_read_b64_tr_b16 v[130:131], v14 offset:5120
    v_mfma_f32_32x32x16_bf16 v[80:95], v[148:151], v[180:183], v[80:95]
    ds_read_b64_tr_b16 v[132:133], v15 offset:4096
    ds_read_b64_tr_b16 v[134:135], v15 offset:5120
    ds_read_b64_tr_b16 v[136:137], v16 offset:4096
    v_mfma_f32_32x32x16_bf16 v[96:111], v[152:155], v[180:183], v[96:111]
    ds_read_b64_tr_b16 v[138:139], v16 offset:5120
    ds_read_b64_tr_b16 v[140:141], v17 offset:4096
    ds_read_b64_tr_b16 v[142:143], v17 offset:5120
    v_mfma_f32_32x32x16_bf16 v[112:127], v[156:159], v[180:183], v[112:127]
    s_waitcnt lgkmcnt(9)
    v_mfma_f32_32x32x16_bf16 v[64:79], v[160:163], v[184:187], v[64:79]
    ds_read_b128 v[180:183], v24 offset:0
    ds_read_b64_tr_b16 v[144:145], v14 offset:8192
    ds_read_b64_tr_b16 v[146:147], v14 offset:9216
    v_mfma_f32_32x32x16_bf16 v[80:95], v[164:167], v[184:187], v[80:95]
    ds_read_b64_tr_b16 v[148:149], v15 offset:8192
    ds_read_b64_tr_b16 v[150:151], v15 offset:9216
    ds_read_b64_tr_b16 v[152:153], v16 offset:8192
    v_mfma_f32_32x32x16_bf16 v[96:111], v[168:171], v[184:187], v[96:111]
    ds_read_b64_tr_b16 v[154:155], v16 offset:9216
    ds_read_b64_tr_b16 v[156:157], v17 offset:8192
    ds_read_b64_tr_b16 v[158:159], v17 offset:9216
    v_mfma_f32_32x32x16_bf16 v[112:127], v[172:175], v[184:187], v[112:127]
    s_waitcnt lgkmcnt(9)
    v_mfma_f32_32x32x16_bf16 v[64:79], v[128:131], v[176:179], v[64:79]
    ds_read_b128 v[184:187], v25 offset:0
    ds_read_b64_tr_b16 v[160:161], v14 offset:12288
    ds_read_b64_tr_b16 v[162:163], v14 offset:13312
    v_mfma_f32_32x32x16_bf16 v[80:95], v[132:135], v[176:179], v[80:95]
    ds_read_b64_tr_b16 v[164:165], v15 offset:12288
    ds_read_b64_tr_b16 v[166:167], v15 offset:13312
    ds_read_b64_tr_b16 v[168:169], v16 offset:12288
    v_mfma_f32_32x32x16_bf16 v[96:111], v[136:139], v[176:179], v[96:111]
    ds_read_b64_tr_b16 v[170:171], v16 offset:13312
    ds_read_b64_tr_b16 v[172:173], v17 offset:12288
    ds_read_b64_tr_b16 v[174:175], v17 offset:13312
    v_mfma_f32_32x32x16_bf16 v[112:127], v[140:143], v[176:179], v[112:127]
    s_waitcnt lgkmcnt(9)
    v_mfma_f32_32x32x16_bf16 v[64:79], v[144:147], v[180:183], v[64:79]
    v_mfma_f32_32x32x16_bf16 v[80:95], v[148:151], v[180:183], v[80:95]
    v_mfma_f32_32x32x16_bf16 v[96:111], v[152:155], v[180:183], v[96:111]
    v_mfma_f32_32x32x16_bf16 v[112:127], v[156:159], v[180:183], v[112:127]
    s_waitcnt lgkmcnt(0)
    v_mfma_f32_32x32x16_bf16 v[64:79], v[160:163], v[184:187], v[64:79]
    v_mfma_f32_32x32x16_bf16 v[80:95], v[164:167], v[184:187], v[80:95]
    v_mfma_f32_32x32x16_bf16 v[96:111], v[168:171], v[184:187], v[96:111]
    v_mfma_f32_32x32x16_bf16 v[112:127], v[172:175], v[184:187], v[112:127]
    s_barrier
    ds_read_b128 v[128:131], v40
    ds_read_b128 v[132:135], v41
    ds_read_b128 v[136:139], v42
    ds_read_b128 v[140:143], v43
    ds_read_b128 v[144:147], v44
    ds_read_b128 v[148:151], v45
    ds_read_b128 v[152:155], v46
    ds_read_b128 v[156:159], v47
    s_nop 7
    v_cvt_pk_bf16_f32 v64, v64, v65
    v_cvt_pk_bf16_f32 v65, v66, v67
    v_cvt_pk_bf16_f32 v66, v68, v69
    v_cvt_pk_bf16_f32 v67, v70, v71
    v_cvt_pk_bf16_f32 v68, v72, v73
    v_cvt_pk_bf16_f32 v69, v74, v75
    v_cvt_pk_bf16_f32 v70, v76, v77
    v_cvt_pk_bf16_f32 v71, v78, v79
    v_cvt_pk_bf16_f32 v72, v80, v81
    v_cvt_pk_bf16_f32 v73, v82, v83
    v_cvt_pk_bf16_f32 v74, v84, v85
    v_cvt_pk_bf16_f32 v75, v86, v87
    v_cvt_pk_bf16_f32 v76, v88, v89
    v_cvt_pk_bf16_f32 v77, v90, v91
    v_cvt_pk_bf16_f32 v78, v92, v93
    v_cvt_pk_bf16_f32 v79, v94, v95
    v_cvt_pk_bf16_f32 v80, v96, v97
    v_cvt_pk_bf16_f32 v81, v98, v99
    v_cvt_pk_bf16_f32 v82, v100, v101
    v_cvt_pk_bf16_f32 v83, v102, v103
    v_cvt_pk_bf16_f32 v84, v104, v105
    v_cvt_pk_bf16_f32 v85, v106, v107
    v_cvt_pk_bf16_f32 v86, v108, v109
    v_cvt_pk_bf16_f32 v87, v110, v111
    v_cvt_pk_bf16_f32 v88, v112, v113
    v_cvt_pk_bf16_f32 v89, v114, v115
    v_cvt_pk_bf16_f32 v90, v116, v117
    v_cvt_pk_bf16_f32 v91, v118, v119
    v_cvt_pk_bf16_f32 v92, v120, v121
    v_cvt_pk_bf16_f32 v93, v122, v123
    v_cvt_pk_bf16_f32 v94, v124, v125
    v_cvt_pk_bf16_f32 v95, v126, v127
    ds_read_b128 v[24:27], v244 offset:0
    ds_read_b128 v[28:31], v244 offset:2048
    ds_read_b64_tr_b16 v[40:41], v248 offset:0
    ds_read_b64_tr_b16 v[42:43], v248 offset:1280
    ds_read_b64_tr_b16 v[44:45], v249 offset:0
    ds_read_b64_tr_b16 v[46:47], v249 offset:1280
    ds_read_b64_tr_b16 v[48:49], v248 offset:64
    ds_read_b64_tr_b16 v[50:51], v248 offset:1344
    ds_read_b64_tr_b16 v[52:53], v249 offset:64
    ds_read_b64_tr_b16 v[54:55], v249 offset:1344
    ds_read_b64_tr_b16 v[56:57], v248 offset:128
    ds_read_b64_tr_b16 v[58:59], v248 offset:1408
    s_waitcnt lgkmcnt(8)
    v_mfma_f32_16x16x32_bf16 v[172:175], v[24:27], v[40:43], 0
    ds_read_b64_tr_b16 v[60:61], v249 offset:128
    v_mfma_f32_16x16x32_bf16 v[176:179], v[28:31], v[40:43], 0
    ds_read_b64_tr_b16 v[62:63], v249 offset:1408
    v_mfma_f32_32x32x16_bf16 v[112:127], v[128:131], v[64:67], 0
    v_mfma_f32_32x32x16_bf16 v[112:127], v[132:135], v[68:71], v[112:127]
    s_waitcnt lgkmcnt(8)
    v_mfma_f32_16x16x32_bf16 v[180:183], v[24:27], v[44:47], 0
    ds_read_b64_tr_b16 v[40:41], v248 offset:192
    v_mfma_f32_16x16x32_bf16 v[184:187], v[28:31], v[44:47], 0
    ds_read_b64_tr_b16 v[42:43], v248 offset:1472
    v_mfma_f32_32x32x16_bf16 v[112:127], v[136:139], v[72:75], v[112:127]
    v_mfma_f32_32x32x16_bf16 v[112:127], v[140:143], v[76:79], v[112:127]
    s_waitcnt lgkmcnt(8)
    v_mfma_f32_16x16x32_bf16 v[188:191], v[24:27], v[48:51], 0
    ds_read_b64_tr_b16 v[44:45], v249 offset:192
    v_mfma_f32_16x16x32_bf16 v[192:195], v[28:31], v[48:51], 0
    ds_read_b64_tr_b16 v[46:47], v249 offset:1472
    v_mfma_f32_32x32x16_bf16 v[112:127], v[144:147], v[80:83], v[112:127]
    v_mfma_f32_32x32x16_bf16 v[112:127], v[148:151], v[84:87], v[112:127]
    ds_read_b128 v[32:35], v245 offset:0
    ds_read_b128 v[36:39], v245 offset:2048
    s_waitcnt lgkmcnt(10)
    v_mfma_f32_16x16x32_bf16 v[196:199], v[24:27], v[52:55], 0
    ds_read_b64_tr_b16 v[48:49], v248 offset:256
    v_mfma_f32_16x16x32_bf16 v[200:203], v[28:31], v[52:55], 0
    ds_read_b64_tr_b16 v[50:51], v248 offset:1536
    v_mfma_f32_32x32x16_bf16 v[112:127], v[152:155], v[88:91], v[112:127]
    v_mfma_f32_32x32x16_bf16 v[112:127], v[156:159], v[92:95], v[112:127]
    s_waitcnt lgkmcnt(10)
    v_mfma_f32_16x16x32_bf16 v[204:207], v[24:27], v[56:59], 0
    ds_read_b64_tr_b16 v[52:53], v248 offset:10240
    v_mfma_f32_16x16x32_bf16 v[208:211], v[28:31], v[56:59], 0
    ds_read_b64_tr_b16 v[54:55], v248 offset:11520
    s_waitcnt lgkmcnt(10)
    v_mfma_f32_16x16x32_bf16 v[212:215], v[24:27], v[60:63], 0
    ds_read_b64_tr_b16 v[56:57], v249 offset:10240
    v_mfma_f32_16x16x32_bf16 v[216:219], v[28:31], v[60:63], 0
    ds_read_b64_tr_b16 v[58:59], v249 offset:11520
    s_waitcnt lgkmcnt(10)
    v_mfma_f32_16x16x32_bf16 v[220:223], v[24:27], v[40:43], 0
    ds_read_b64_tr_b16 v[60:61], v248 offset:10304
    v_mfma_f32_16x16x32_bf16 v[224:227], v[28:31], v[40:43], 0
    ds_read_b64_tr_b16 v[62:63], v248 offset:11584
    v_max_f32 v3, v112, v113
    v_max3_f32 v3, v3, v114, v115
    v_max3_f32 v3, v3, v116, v117
    v_max3_f32 v3, v3, v118, v119
    s_waitcnt lgkmcnt(10)
    v_mfma_f32_16x16x32_bf16 v[228:231], v[24:27], v[44:47], 0
    ds_read_b64_tr_b16 v[40:41], v249 offset:10304
    v_mfma_f32_16x16x32_bf16 v[232:235], v[28:31], v[44:47], 0
    ds_read_b64_tr_b16 v[42:43], v249 offset:11584
    v_max3_f32 v3, v3, v120, v121
    v_max3_f32 v3, v3, v122, v123
    v_max3_f32 v3, v3, v124, v125
    v_max3_f32 v3, v3, v126, v127
    s_waitcnt lgkmcnt(8)
    v_mfma_f32_16x16x32_bf16 v[236:239], v[24:27], v[48:51], 0
    ds_read_b64_tr_b16 v[44:45], v248 offset:10368
    v_mfma_f32_16x16x32_bf16 v[240:243], v[28:31], v[48:51], 0
    ds_read_b64_tr_b16 v[46:47], v248 offset:11648
    v_mov_b32 v4, v3
    s_nop 1
    v_permlane32_swap_b32 v3, v4
    s_waitcnt lgkmcnt(8)
    v_mfma_f32_16x16x32_bf16 v[172:175], v[32:35], v[52:55], v[172:175]
    ds_read_b64_tr_b16 v[48:49], v249 offset:10368
    v_mfma_f32_16x16x32_bf16 v[176:179], v[36:39], v[52:55], v[176:179]
    ds_read_b64_tr_b16 v[50:51], v249 offset:11648
    v_max_f32 v3, v3, v4
    v_mul_f32 v3, s52, v3
    s_waitcnt lgkmcnt(8)
    v_mfma_f32_16x16x32_bf16 v[180:183], v[32:35], v[56:59], v[180:183]
    ds_read_b64_tr_b16 v[52:53], v248 offset:10432
    v_mfma_f32_16x16x32_bf16 v[184:187], v[36:39], v[56:59], v[184:187]
    ds_read_b64_tr_b16 v[54:55], v248 offset:11712
    v_fma_f32 v112, v112, s52, -v3
    v_fma_f32 v113, v113, s52, -v3
    v_fma_f32 v114, v114, s52, -v3
    v_fma_f32 v115, v115, s52, -v3
    v_fma_f32 v116, v116, s52, -v3
    v_fma_f32 v117, v117, s52, -v3
    s_waitcnt lgkmcnt(8)
    v_mfma_f32_16x16x32_bf16 v[188:191], v[32:35], v[60:63], v[188:191]
    ds_read_b64_tr_b16 v[56:57], v249 offset:10432
    v_mfma_f32_16x16x32_bf16 v[192:195], v[36:39], v[60:63], v[192:195]
    ds_read_b64_tr_b16 v[58:59], v249 offset:11712
    v_fma_f32 v118, v118, s52, -v3
    v_fma_f32 v119, v119, s52, -v3
    v_fma_f32 v120, v120, s52, -v3
    v_fma_f32 v121, v121, s52, -v3
    v_fma_f32 v122, v122, s52, -v3
    s_barrier
    ds_read_b128 v[24:27], v244 offset:16384
    ds_read_b128 v[28:31], v244 offset:18432
    s_waitcnt lgkmcnt(10)
    v_mfma_f32_16x16x32_bf16 v[196:199], v[32:35], v[40:43], v[196:199]
    ds_read_b64_tr_b16 v[60:61], v248 offset:10496
    v_mfma_f32_16x16x32_bf16 v[200:203], v[36:39], v[40:43], v[200:203]
    ds_read_b64_tr_b16 v[62:63], v248 offset:11776
    v_fma_f32 v123, v123, s52, -v3
    v_fma_f32 v124, v124, s52, -v3
    v_fma_f32 v125, v125, s52, -v3
    v_fma_f32 v126, v126, s52, -v3
    v_fma_f32 v127, v127, s52, -v3
    s_waitcnt lgkmcnt(10)
    v_mfma_f32_16x16x32_bf16 v[204:207], v[32:35], v[44:47], v[204:207]
    ds_read_b64_tr_b16 v[40:41], v248 offset:20480
    v_mfma_f32_16x16x32_bf16 v[208:211], v[36:39], v[44:47], v[208:211]
    ds_read_b64_tr_b16 v[42:43], v248 offset:21760
    v_exp_f32 v112, v112
    v_exp_f32 v113, v113
    v_exp_f32 v114, v114
    v_exp_f32 v115, v115
    s_waitcnt lgkmcnt(10)
    v_mfma_f32_16x16x32_bf16 v[212:215], v[32:35], v[48:51], v[212:215]
    ds_read_b64_tr_b16 v[44:45], v249 offset:20480
    v_mfma_f32_16x16x32_bf16 v[216:219], v[36:39], v[48:51], v[216:219]
    ds_read_b64_tr_b16 v[46:47], v249 offset:21760
    v_exp_f32 v116, v116
    v_exp_f32 v117, v117
    v_exp_f32 v118, v118
    v_exp_f32 v119, v119
    s_waitcnt lgkmcnt(10)
    v_mfma_f32_16x16x32_bf16 v[220:223], v[32:35], v[52:55], v[220:223]
    ds_read_b64_tr_b16 v[48:49], v248 offset:20544
    v_mfma_f32_16x16x32_bf16 v[224:227], v[36:39], v[52:55], v[224:227]
    ds_read_b64_tr_b16 v[50:51], v248 offset:21824
    v_exp_f32 v120, v120
    v_exp_f32 v121, v121
    v_exp_f32 v122, v122
    v_exp_f32 v123, v123
    s_waitcnt lgkmcnt(10)
    v_mfma_f32_16x16x32_bf16 v[228:231], v[32:35], v[56:59], v[228:231]
    ds_read_b64_tr_b16 v[52:53], v249 offset:20544
    v_mfma_f32_16x16x32_bf16 v[232:235], v[36:39], v[56:59], v[232:235]
    ds_read_b64_tr_b16 v[54:55], v249 offset:21824
    v_exp_f32 v124, v124
    v_exp_f32 v125, v125
    v_exp_f32 v126, v126
    v_exp_f32 v127, v127
    s_waitcnt lgkmcnt(8)
    v_mfma_f32_16x16x32_bf16 v[236:239], v[32:35], v[60:63], v[236:239]
    ds_read_b64_tr_b16 v[56:57], v248 offset:20608
    v_mfma_f32_16x16x32_bf16 v[240:243], v[36:39], v[60:63], v[240:243]
    ds_read_b64_tr_b16 v[58:59], v248 offset:21888
    v_add_f32 v5, v112, v113
    v_add_f32 v6, v114, v115
    v_add_f32 v5, v5, v116
    v_add_f32 v6, v6, v117
    v_add_f32 v5, v5, v118
    s_waitcnt lgkmcnt(8)
    v_mfma_f32_16x16x32_bf16 v[172:175], v[24:27], v[40:43], v[172:175]
    ds_read_b64_tr_b16 v[60:61], v249 offset:20608
    v_mfma_f32_16x16x32_bf16 v[176:179], v[28:31], v[40:43], v[176:179]
    ds_read_b64_tr_b16 v[62:63], v249 offset:21888
    v_add_f32 v6, v6, v119
    v_add_f32 v5, v5, v120
    v_add_f32 v6, v6, v121
    v_add_f32 v5, v5, v122
    v_add_f32 v6, v6, v123
    s_waitcnt lgkmcnt(8)
    v_mfma_f32_16x16x32_bf16 v[180:183], v[24:27], v[44:47], v[180:183]
    ds_read_b64_tr_b16 v[40:41], v248 offset:20672
    v_mfma_f32_16x16x32_bf16 v[184:187], v[28:31], v[44:47], v[184:187]
    ds_read_b64_tr_b16 v[42:43], v248 offset:21952
    v_add_f32 v5, v5, v124
    v_add_f32 v6, v6, v125
    v_add_f32 v5, v5, v126
    v_add_f32 v6, v6, v127
    s_waitcnt lgkmcnt(8)
    v_mfma_f32_16x16x32_bf16 v[188:191], v[24:27], v[48:51], v[188:191]
    ds_read_b64_tr_b16 v[44:45], v249 offset:20672
    v_mfma_f32_16x16x32_bf16 v[192:195], v[28:31], v[48:51], v[192:195]
    ds_read_b64_tr_b16 v[46:47], v249 offset:21952
    v_add_f32 v5, v5, v6
    s_nop 0
    v_mov_b32 v6, v5
    s_nop 1
    v_permlane32_swap_b32 v5, v6
    ds_read_b128 v[32:35], v245 offset:16384
    ds_read_b128 v[36:39], v245 offset:18432
    s_waitcnt lgkmcnt(10)
    v_mfma_f32_16x16x32_bf16 v[196:199], v[24:27], v[52:55], v[196:199]
    ds_read_b64_tr_b16 v[48:49], v248 offset:20736
    v_mfma_f32_16x16x32_bf16 v[200:203], v[28:31], v[52:55], v[200:203]
    ds_read_b64_tr_b16 v[50:51], v248 offset:22016
    v_add_f32 v5, v5, v6
    v_rcp_f32 v5, v5
    s_waitcnt lgkmcnt(10)
    v_mfma_f32_16x16x32_bf16 v[204:207], v[24:27], v[56:59], v[204:207]
    ds_read_b64_tr_b16 v[52:53], v248 offset:30720
    v_mfma_f32_16x16x32_bf16 v[208:211], v[28:31], v[56:59], v[208:211]
    ds_read_b64_tr_b16 v[54:55], v248 offset:32000
    v_mul_f32 v112, v112, v5
    v_mul_f32 v113, v113, v5
    v_mul_f32 v114, v114, v5
    v_mul_f32 v115, v115, v5
    v_mul_f32 v116, v116, v5
    v_mul_f32 v117, v117, v5
    s_waitcnt lgkmcnt(10)
    v_mfma_f32_16x16x32_bf16 v[212:215], v[24:27], v[60:63], v[212:215]
    ds_read_b64_tr_b16 v[56:57], v249 offset:30720
    v_mfma_f32_16x16x32_bf16 v[216:219], v[28:31], v[60:63], v[216:219]
    ds_read_b64_tr_b16 v[58:59], v249 offset:32000
    v_mul_f32 v118, v118, v5
    v_mul_f32 v119, v119, v5
    v_mul_f32 v120, v120, v5
    v_mul_f32 v121, v121, v5
    v_mul_f32 v122, v122, v5
    s_waitcnt lgkmcnt(10)
    v_mfma_f32_16x16x32_bf16 v[220:223], v[24:27], v[40:43], v[220:223]
    ds_read_b64_tr_b16 v[60:61], v248 offset:30784
    v_mfma_f32_16x16x32_bf16 v[224:227], v[28:31], v[40:43], v[224:227]
    ds_read_b64_tr_b16 v[62:63], v248 offset:32064
    v_mul_f32 v123, v123, v5
    v_mul_f32 v124, v124, v5
    v_mul_f32 v125, v125, v5
    v_mul_f32 v126, v126, v5
    v_mul_f32 v127, v127, v5
    s_waitcnt lgkmcnt(10)
    v_mfma_f32_16x16x32_bf16 v[228:231], v[24:27], v[44:47], v[228:231]
    ds_read_b64_tr_b16 v[40:41], v249 offset:30784
    v_mfma_f32_16x16x32_bf16 v[232:235], v[28:31], v[44:47], v[232:235]
    ds_read_b64_tr_b16 v[42:43], v249 offset:32064
    v_cvt_pk_bf16_f32 v96, v112, v113
    v_cvt_pk_bf16_f32 v97, v114, v115
    v_cvt_pk_bf16_f32 v98, v120, v121
    v_cvt_pk_bf16_f32 v99, v122, v123
    v_cvt_pk_bf16_f32 v100, v116, v117
    v_cvt_pk_bf16_f32 v101, v118, v119
    v_cvt_pk_bf16_f32 v102, v124, v125
    v_cvt_pk_bf16_f32 v103, v126, v127
    s_waitcnt lgkmcnt(8)
    v_mfma_f32_16x16x32_bf16 v[236:239], v[24:27], v[48:51], v[236:239]
    ds_read_b64_tr_b16 v[44:45], v248 offset:30848
    v_mfma_f32_16x16x32_bf16 v[240:243], v[28:31], v[48:51], v[240:243]
    ds_read_b64_tr_b16 v[46:47], v248 offset:32128
    ds_write_b128 v252, v[96:99]
    ds_write_b128 v252, v[100:103] offset:512
    s_waitcnt lgkmcnt(10)
    v_mfma_f32_16x16x32_bf16 v[172:175], v[32:35], v[52:55], v[172:175]
    ds_read_b64_tr_b16 v[48:49], v249 offset:30848
    v_mfma_f32_16x16x32_bf16 v[176:179], v[36:39], v[52:55], v[176:179]
    ds_read_b64_tr_b16 v[50:51], v249 offset:32128
    s_waitcnt lgkmcnt(10)
    v_mfma_f32_16x16x32_bf16 v[180:183], v[32:35], v[56:59], v[180:183]
    ds_read_b64_tr_b16 v[52:53], v248 offset:30912
    v_mfma_f32_16x16x32_bf16 v[184:187], v[36:39], v[56:59], v[184:187]
    ds_read_b64_tr_b16 v[54:55], v248 offset:32192
    s_waitcnt lgkmcnt(10)
    v_mfma_f32_16x16x32_bf16 v[188:191], v[32:35], v[60:63], v[188:191]
    ds_read_b64_tr_b16 v[56:57], v249 offset:30912
    v_mfma_f32_16x16x32_bf16 v[192:195], v[36:39], v[60:63], v[192:195]
    ds_read_b64_tr_b16 v[58:59], v249 offset:32192
    s_waitcnt lgkmcnt(6)
    s_barrier
    ds_read_b128 v[24:27], v244 offset:32768
    ds_read_b128 v[28:31], v244 offset:34816
    v_mfma_f32_16x16x32_bf16 v[196:199], v[32:35], v[40:43], v[196:199]
    ds_read_b64_tr_b16 v[60:61], v248 offset:30976
    v_cvt_pk_bf16_f32 v64, v172, v173
    v_cvt_pk_bf16_f32 v65, v174, v175
    v_cvt_pk_bf16_f32 v66, v176, v177
    v_cvt_pk_bf16_f32 v67, v178, v179
    v_mfma_f32_16x16x32_bf16 v[200:203], v[36:39], v[40:43], v[200:203]
    ds_read_b64_tr_b16 v[62:63], v248 offset:32256
    v_mfma_f32_16x16x32_bf16 v[204:207], v[32:35], v[44:47], v[204:207]
    ds_read_b64_tr_b16 v[40:41], v246 offset:0
    v_cvt_pk_bf16_f32 v68, v180, v181
    v_cvt_pk_bf16_f32 v69, v182, v183
    v_cvt_pk_bf16_f32 v70, v184, v185
    v_cvt_pk_bf16_f32 v71, v186, v187
    v_mfma_f32_16x16x32_bf16 v[208:211], v[36:39], v[44:47], v[208:211]
    ds_read_b64_tr_b16 v[42:43], v246 offset:1280
    s_waitcnt lgkmcnt(10)
    v_mfma_f32_16x16x32_bf16 v[212:215], v[32:35], v[48:51], v[212:215]
    ds_read_b64_tr_b16 v[44:45], v247 offset:0
    v_cvt_pk_bf16_f32 v72, v188, v189
    v_cvt_pk_bf16_f32 v73, v190, v191
    v_cvt_pk_bf16_f32 v74, v192, v193
    v_cvt_pk_bf16_f32 v75, v194, v195
    v_mfma_f32_16x16x32_bf16 v[216:219], v[36:39], v[48:51], v[216:219]
    ds_read_b64_tr_b16 v[46:47], v247 offset:1280
    s_waitcnt lgkmcnt(10)
    v_mfma_f32_16x16x32_bf16 v[220:223], v[32:35], v[52:55], v[220:223]
    ds_read_b64_tr_b16 v[48:49], v246 offset:64
    v_cvt_pk_bf16_f32 v76, v196, v197
    v_cvt_pk_bf16_f32 v77, v198, v199
    v_cvt_pk_bf16_f32 v78, v200, v201
    v_cvt_pk_bf16_f32 v79, v202, v203
    v_mfma_f32_16x16x32_bf16 v[224:227], v[36:39], v[52:55], v[224:227]
    ds_read_b64_tr_b16 v[50:51], v246 offset:1344
    s_waitcnt lgkmcnt(10)
    v_mfma_f32_16x16x32_bf16 v[228:231], v[32:35], v[56:59], v[228:231]
    ds_read_b64_tr_b16 v[52:53], v247 offset:64
    v_cvt_pk_bf16_f32 v80, v204, v205
    v_cvt_pk_bf16_f32 v81, v206, v207
    v_cvt_pk_bf16_f32 v82, v208, v209
    v_cvt_pk_bf16_f32 v83, v210, v211
    v_mfma_f32_16x16x32_bf16 v[232:235], v[36:39], v[56:59], v[232:235]
    ds_read_b64_tr_b16 v[54:55], v247 offset:1344
    s_waitcnt lgkmcnt(8)
    v_mfma_f32_16x16x32_bf16 v[236:239], v[32:35], v[60:63], v[236:239]
    ds_read_b64_tr_b16 v[56:57], v246 offset:128
    v_cvt_pk_bf16_f32 v84, v212, v213
    v_cvt_pk_bf16_f32 v85, v214, v215
    v_cvt_pk_bf16_f32 v86, v216, v217
    v_cvt_pk_bf16_f32 v87, v218, v219
    v_mfma_f32_16x16x32_bf16 v[240:243], v[36:39], v[60:63], v[240:243]
    ds_read_b64_tr_b16 v[58:59], v246 offset:1408
    s_waitcnt lgkmcnt(8)
    v_mfma_f32_16x16x32_bf16 v[172:175], v[24:27], v[40:43], 0
    ds_read_b64_tr_b16 v[60:61], v247 offset:128
    v_cvt_pk_bf16_f32 v88, v220, v221
    v_cvt_pk_bf16_f32 v89, v222, v223
    v_cvt_pk_bf16_f32 v90, v224, v225
    v_cvt_pk_bf16_f32 v91, v226, v227
    v_mfma_f32_16x16x32_bf16 v[176:179], v[28:31], v[40:43], 0
    ds_read_b64_tr_b16 v[62:63], v247 offset:1408
    s_waitcnt lgkmcnt(8)
    v_mfma_f32_16x16x32_bf16 v[180:183], v[24:27], v[44:47], 0
    ds_read_b64_tr_b16 v[40:41], v246 offset:192
    v_cvt_pk_bf16_f32 v92, v228, v229
    v_cvt_pk_bf16_f32 v93, v230, v231
    v_cvt_pk_bf16_f32 v94, v232, v233
    v_cvt_pk_bf16_f32 v95, v234, v235
    v_mfma_f32_16x16x32_bf16 v[184:187], v[28:31], v[44:47], 0
    ds_read_b64_tr_b16 v[42:43], v246 offset:1472
    s_waitcnt lgkmcnt(8)
    v_mfma_f32_16x16x32_bf16 v[188:191], v[24:27], v[48:51], 0
    ds_read_b64_tr_b16 v[44:45], v247 offset:192
    v_cvt_pk_bf16_f32 v96, v236, v237
    v_cvt_pk_bf16_f32 v97, v238, v239
    v_cvt_pk_bf16_f32 v98, v240, v241
    v_cvt_pk_bf16_f32 v99, v242, v243
    v_mfma_f32_16x16x32_bf16 v[192:195], v[28:31], v[48:51], 0
    ds_read_b64_tr_b16 v[46:47], v247 offset:1472
    ds_read_b128 v[32:35], v245 offset:32768
    ds_read_b128 v[36:39], v245 offset:34816
    s_waitcnt lgkmcnt(10)
    v_mfma_f32_16x16x32_bf16 v[196:199], v[24:27], v[52:55], 0
    ds_read_b64_tr_b16 v[48:49], v246 offset:256
    v_mfma_f32_16x16x32_bf16 v[200:203], v[28:31], v[52:55], 0
    ds_read_b64_tr_b16 v[50:51], v246 offset:1536
    s_waitcnt lgkmcnt(10)
    v_mfma_f32_16x16x32_bf16 v[204:207], v[24:27], v[56:59], 0
    ds_read_b64_tr_b16 v[52:53], v246 offset:10240
    v_mfma_f32_16x16x32_bf16 v[208:211], v[28:31], v[56:59], 0
    ds_read_b64_tr_b16 v[54:55], v246 offset:11520
    s_waitcnt lgkmcnt(10)
    v_mfma_f32_16x16x32_bf16 v[212:215], v[24:27], v[60:63], 0
    ds_read_b64_tr_b16 v[56:57], v247 offset:10240
    v_mfma_f32_16x16x32_bf16 v[216:219], v[28:31], v[60:63], 0
    ds_read_b64_tr_b16 v[58:59], v247 offset:11520
    s_waitcnt lgkmcnt(10)
    v_mfma_f32_16x16x32_bf16 v[220:223], v[24:27], v[40:43], 0
    ds_read_b64_tr_b16 v[60:61], v246 offset:10304
    v_mfma_f32_16x16x32_bf16 v[224:227], v[28:31], v[40:43], 0
    ds_read_b64_tr_b16 v[62:63], v246 offset:11584
    s_waitcnt lgkmcnt(10)
    v_mfma_f32_16x16x32_bf16 v[228:231], v[24:27], v[44:47], 0
    ds_read_b64_tr_b16 v[40:41], v247 offset:10304
    v_mfma_f32_16x16x32_bf16 v[232:235], v[28:31], v[44:47], 0
    ds_read_b64_tr_b16 v[42:43], v247 offset:11584
    s_waitcnt lgkmcnt(8)
    v_mfma_f32_16x16x32_bf16 v[236:239], v[24:27], v[48:51], 0
    ds_read_b64_tr_b16 v[44:45], v246 offset:10368
    v_mfma_f32_16x16x32_bf16 v[240:243], v[28:31], v[48:51], 0
    ds_read_b64_tr_b16 v[46:47], v246 offset:11648
    s_waitcnt lgkmcnt(8)
    v_mfma_f32_16x16x32_bf16 v[172:175], v[32:35], v[52:55], v[172:175]
    ds_read_b64_tr_b16 v[48:49], v247 offset:10368
    v_mfma_f32_16x16x32_bf16 v[176:179], v[36:39], v[52:55], v[176:179]
    ds_read_b64_tr_b16 v[50:51], v247 offset:11648
    s_waitcnt lgkmcnt(8)
    v_mfma_f32_16x16x32_bf16 v[180:183], v[32:35], v[56:59], v[180:183]
    ds_read_b64_tr_b16 v[52:53], v246 offset:10432
    v_mfma_f32_16x16x32_bf16 v[184:187], v[36:39], v[56:59], v[184:187]
    ds_read_b64_tr_b16 v[54:55], v246 offset:11712
    s_waitcnt lgkmcnt(8)
    v_mfma_f32_16x16x32_bf16 v[188:191], v[32:35], v[60:63], v[188:191]
    ds_read_b64_tr_b16 v[56:57], v247 offset:10432
    v_mfma_f32_16x16x32_bf16 v[192:195], v[36:39], v[60:63], v[192:195]
    ds_read_b64_tr_b16 v[58:59], v247 offset:11712
    s_barrier
    ds_read_b128 v[24:27], v244 offset:0
    ds_read_b128 v[28:31], v244 offset:2048
    s_waitcnt lgkmcnt(10)
    v_mfma_f32_16x16x32_bf16 v[196:199], v[32:35], v[40:43], v[196:199]
    ds_read_b64_tr_b16 v[60:61], v246 offset:10496
    v_mfma_f32_16x16x32_bf16 v[200:203], v[36:39], v[40:43], v[200:203]
    ds_read_b64_tr_b16 v[62:63], v246 offset:11776
    s_waitcnt lgkmcnt(10)
    v_mfma_f32_16x16x32_bf16 v[204:207], v[32:35], v[44:47], v[204:207]
    ds_read_b64_tr_b16 v[40:41], v246 offset:20480
    v_mfma_f32_16x16x32_bf16 v[208:211], v[36:39], v[44:47], v[208:211]
    ds_read_b64_tr_b16 v[42:43], v246 offset:21760
    s_waitcnt lgkmcnt(10)
    v_mfma_f32_16x16x32_bf16 v[212:215], v[32:35], v[48:51], v[212:215]
    ds_read_b64_tr_b16 v[44:45], v247 offset:20480
    v_mfma_f32_16x16x32_bf16 v[216:219], v[36:39], v[48:51], v[216:219]
    ds_read_b64_tr_b16 v[46:47], v247 offset:21760
    s_waitcnt lgkmcnt(10)
    v_mfma_f32_16x16x32_bf16 v[220:223], v[32:35], v[52:55], v[220:223]
    ds_read_b64_tr_b16 v[48:49], v246 offset:20544
    v_mfma_f32_16x16x32_bf16 v[224:227], v[36:39], v[52:55], v[224:227]
    ds_read_b64_tr_b16 v[50:51], v246 offset:21824
    s_waitcnt lgkmcnt(10)
    v_mfma_f32_16x16x32_bf16 v[228:231], v[32:35], v[56:59], v[228:231]
    ds_read_b64_tr_b16 v[52:53], v247 offset:20544
    v_mfma_f32_16x16x32_bf16 v[232:235], v[36:39], v[56:59], v[232:235]
    ds_read_b64_tr_b16 v[54:55], v247 offset:21824
    s_waitcnt lgkmcnt(8)
    v_mfma_f32_16x16x32_bf16 v[236:239], v[32:35], v[60:63], v[236:239]
    ds_read_b64_tr_b16 v[56:57], v246 offset:20608
    v_mfma_f32_16x16x32_bf16 v[240:243], v[36:39], v[60:63], v[240:243]
    ds_read_b64_tr_b16 v[58:59], v246 offset:21888
    s_waitcnt lgkmcnt(8)
    v_mfma_f32_16x16x32_bf16 v[172:175], v[24:27], v[40:43], v[172:175]
    ds_read_b64_tr_b16 v[60:61], v247 offset:20608
    v_mfma_f32_16x16x32_bf16 v[176:179], v[28:31], v[40:43], v[176:179]
    ds_read_b64_tr_b16 v[62:63], v247 offset:21888
    s_waitcnt lgkmcnt(8)
    v_mfma_f32_16x16x32_bf16 v[180:183], v[24:27], v[44:47], v[180:183]
    ds_read_b64_tr_b16 v[40:41], v246 offset:20672
    v_mfma_f32_16x16x32_bf16 v[184:187], v[28:31], v[44:47], v[184:187]
    ds_read_b64_tr_b16 v[42:43], v246 offset:21952
    s_waitcnt lgkmcnt(8)
    v_mfma_f32_16x16x32_bf16 v[188:191], v[24:27], v[48:51], v[188:191]
    ds_read_b64_tr_b16 v[44:45], v247 offset:20672
    v_mfma_f32_16x16x32_bf16 v[192:195], v[28:31], v[48:51], v[192:195]
    ds_read_b64_tr_b16 v[46:47], v247 offset:21952
    ds_read_b128 v[32:35], v245 offset:0
    ds_read_b128 v[36:39], v245 offset:2048
    s_waitcnt lgkmcnt(10)
    v_mfma_f32_16x16x32_bf16 v[196:199], v[24:27], v[52:55], v[196:199]
    ds_read_b64_tr_b16 v[48:49], v246 offset:20736
    v_mfma_f32_16x16x32_bf16 v[200:203], v[28:31], v[52:55], v[200:203]
    ds_read_b64_tr_b16 v[50:51], v246 offset:22016
    s_waitcnt lgkmcnt(10)
    v_mfma_f32_16x16x32_bf16 v[204:207], v[24:27], v[56:59], v[204:207]
    ds_read_b64_tr_b16 v[52:53], v246 offset:30720
    v_mfma_f32_16x16x32_bf16 v[208:211], v[28:31], v[56:59], v[208:211]
    ds_read_b64_tr_b16 v[54:55], v246 offset:32000
    s_waitcnt lgkmcnt(10)
    v_mfma_f32_16x16x32_bf16 v[212:215], v[24:27], v[60:63], v[212:215]
    ds_read_b64_tr_b16 v[56:57], v247 offset:30720
    v_mfma_f32_16x16x32_bf16 v[216:219], v[28:31], v[60:63], v[216:219]
    ds_read_b64_tr_b16 v[58:59], v247 offset:32000
    s_waitcnt lgkmcnt(10)
    v_mfma_f32_16x16x32_bf16 v[220:223], v[24:27], v[40:43], v[220:223]
    ds_read_b64_tr_b16 v[60:61], v246 offset:30784
    v_mfma_f32_16x16x32_bf16 v[224:227], v[28:31], v[40:43], v[224:227]
    ds_read_b64_tr_b16 v[62:63], v246 offset:32064
    s_waitcnt lgkmcnt(10)
    v_mfma_f32_16x16x32_bf16 v[228:231], v[24:27], v[44:47], v[228:231]
    ds_read_b64_tr_b16 v[40:41], v247 offset:30784
    v_mfma_f32_16x16x32_bf16 v[232:235], v[28:31], v[44:47], v[232:235]
    ds_read_b64_tr_b16 v[42:43], v247 offset:32064
    s_waitcnt lgkmcnt(8)
    v_mfma_f32_16x16x32_bf16 v[236:239], v[24:27], v[48:51], v[236:239]
    ds_read_b64_tr_b16 v[44:45], v246 offset:30848
    v_mfma_f32_16x16x32_bf16 v[240:243], v[28:31], v[48:51], v[240:243]
    ds_read_b64_tr_b16 v[46:47], v246 offset:32128
    s_waitcnt lgkmcnt(8)
    v_mfma_f32_16x16x32_bf16 v[172:175], v[32:35], v[52:55], v[172:175]
    ds_read_b64_tr_b16 v[48:49], v247 offset:30848
    v_mfma_f32_16x16x32_bf16 v[176:179], v[36:39], v[52:55], v[176:179]
    ds_read_b64_tr_b16 v[50:51], v247 offset:32128
    s_waitcnt lgkmcnt(8)
    v_mfma_f32_16x16x32_bf16 v[180:183], v[32:35], v[56:59], v[180:183]
    ds_read_b64_tr_b16 v[52:53], v246 offset:30912
    v_mfma_f32_16x16x32_bf16 v[184:187], v[36:39], v[56:59], v[184:187]
    ds_read_b64_tr_b16 v[54:55], v246 offset:32192
    s_waitcnt lgkmcnt(8)
    v_mfma_f32_16x16x32_bf16 v[188:191], v[32:35], v[60:63], v[188:191]
    ds_read_b64_tr_b16 v[56:57], v247 offset:30912
    v_mfma_f32_16x16x32_bf16 v[192:195], v[36:39], v[60:63], v[192:195]
    ds_read_b64_tr_b16 v[58:59], v247 offset:32192
    s_barrier
    ds_read_b128 v[24:27], v244 offset:16384
    ds_read_b128 v[28:31], v244 offset:18432
    s_waitcnt lgkmcnt(10)
    v_mfma_f32_16x16x32_bf16 v[196:199], v[32:35], v[40:43], v[196:199]
    ds_read_b64_tr_b16 v[60:61], v246 offset:30976
    v_cvt_pk_bf16_f32 v100, v172, v173
    v_cvt_pk_bf16_f32 v101, v174, v175
    v_cvt_pk_bf16_f32 v102, v176, v177
    v_cvt_pk_bf16_f32 v103, v178, v179
    v_mfma_f32_16x16x32_bf16 v[200:203], v[36:39], v[40:43], v[200:203]
    ds_read_b64_tr_b16 v[62:63], v246 offset:32256
    s_waitcnt lgkmcnt(10)
    v_mfma_f32_16x16x32_bf16 v[204:207], v[32:35], v[44:47], v[204:207]
    ds_read_b64_tr_b16 v[40:41], v248 offset:0
    v_cvt_pk_bf16_f32 v104, v180, v181
    v_cvt_pk_bf16_f32 v105, v182, v183
    v_cvt_pk_bf16_f32 v106, v184, v185
    v_cvt_pk_bf16_f32 v107, v186, v187
    v_mfma_f32_16x16x32_bf16 v[208:211], v[36:39], v[44:47], v[208:211]
    ds_read_b64_tr_b16 v[42:43], v248 offset:1280
    s_waitcnt lgkmcnt(10)
    v_mfma_f32_16x16x32_bf16 v[212:215], v[32:35], v[48:51], v[212:215]
    ds_read_b64_tr_b16 v[44:45], v249 offset:0
    v_cvt_pk_bf16_f32 v108, v188, v189
    v_cvt_pk_bf16_f32 v109, v190, v191
    v_cvt_pk_bf16_f32 v110, v192, v193
    v_cvt_pk_bf16_f32 v111, v194, v195
    v_mfma_f32_16x16x32_bf16 v[216:219], v[36:39], v[48:51], v[216:219]
    ds_read_b64_tr_b16 v[46:47], v249 offset:1280
    s_waitcnt lgkmcnt(10)
    v_mfma_f32_16x16x32_bf16 v[220:223], v[32:35], v[52:55], v[220:223]
    ds_read_b64_tr_b16 v[48:49], v248 offset:64
    v_cvt_pk_bf16_f32 v112, v196, v197
    v_cvt_pk_bf16_f32 v113, v198, v199
    v_cvt_pk_bf16_f32 v114, v200, v201
    v_cvt_pk_bf16_f32 v115, v202, v203
    v_mfma_f32_16x16x32_bf16 v[224:227], v[36:39], v[52:55], v[224:227]
    ds_read_b64_tr_b16 v[50:51], v248 offset:1344
    s_waitcnt lgkmcnt(10)
    v_mfma_f32_16x16x32_bf16 v[228:231], v[32:35], v[56:59], v[228:231]
    ds_read_b64_tr_b16 v[52:53], v249 offset:64
    v_cvt_pk_bf16_f32 v116, v204, v205
    v_cvt_pk_bf16_f32 v117, v206, v207
    v_cvt_pk_bf16_f32 v118, v208, v209
    v_cvt_pk_bf16_f32 v119, v210, v211
    v_mfma_f32_16x16x32_bf16 v[232:235], v[36:39], v[56:59], v[232:235]
    ds_read_b64_tr_b16 v[54:55], v249 offset:1344
    s_waitcnt lgkmcnt(8)
    v_mfma_f32_16x16x32_bf16 v[236:239], v[32:35], v[60:63], v[236:239]
    ds_read_b64_tr_b16 v[56:57], v248 offset:128
    v_cvt_pk_bf16_f32 v120, v212, v213
    v_cvt_pk_bf16_f32 v121, v214, v215
    v_cvt_pk_bf16_f32 v122, v216, v217
    v_cvt_pk_bf16_f32 v123, v218, v219
    v_mfma_f32_16x16x32_bf16 v[240:243], v[36:39], v[60:63], v[240:243]
    ds_read_b64_tr_b16 v[58:59], v248 offset:1408
    s_waitcnt lgkmcnt(8)
    v_mfma_f32_16x16x32_bf16 v[172:175], v[24:27], v[40:43], 0
    ds_read_b64_tr_b16 v[60:61], v249 offset:128
    v_cvt_pk_bf16_f32 v124, v220, v221
    v_cvt_pk_bf16_f32 v125, v222, v223
    v_cvt_pk_bf16_f32 v126, v224, v225
    v_cvt_pk_bf16_f32 v127, v226, v227
    v_mfma_f32_16x16x32_bf16 v[176:179], v[28:31], v[40:43], 0
    ds_read_b64_tr_b16 v[62:63], v249 offset:1408
    s_waitcnt lgkmcnt(8)
    v_mfma_f32_16x16x32_bf16 v[180:183], v[24:27], v[44:47], 0
    ds_read_b64_tr_b16 v[40:41], v248 offset:192
    v_cvt_pk_bf16_f32 v128, v228, v229
    v_cvt_pk_bf16_f32 v129, v230, v231
    v_cvt_pk_bf16_f32 v130, v232, v233
    v_cvt_pk_bf16_f32 v131, v234, v235
    v_mfma_f32_16x16x32_bf16 v[184:187], v[28:31], v[44:47], 0
    ds_read_b64_tr_b16 v[42:43], v248 offset:1472
    s_waitcnt lgkmcnt(8)
    v_mfma_f32_16x16x32_bf16 v[188:191], v[24:27], v[48:51], 0
    ds_read_b64_tr_b16 v[44:45], v249 offset:192
    v_cvt_pk_bf16_f32 v132, v236, v237
    v_cvt_pk_bf16_f32 v133, v238, v239
    v_cvt_pk_bf16_f32 v134, v240, v241
    v_cvt_pk_bf16_f32 v135, v242, v243
    v_mfma_f32_16x16x32_bf16 v[192:195], v[28:31], v[48:51], 0
    ds_read_b64_tr_b16 v[46:47], v249 offset:1472
    ds_read_b128 v[32:35], v245 offset:16384
    ds_read_b128 v[36:39], v245 offset:18432
    s_waitcnt lgkmcnt(10)
    v_mfma_f32_16x16x32_bf16 v[196:199], v[24:27], v[52:55], 0
    ds_read_b64_tr_b16 v[48:49], v248 offset:256
    v_mfma_f32_16x16x32_bf16 v[200:203], v[28:31], v[52:55], 0
    ds_read_b64_tr_b16 v[50:51], v248 offset:1536
    s_waitcnt lgkmcnt(10)
    v_mfma_f32_16x16x32_bf16 v[204:207], v[24:27], v[56:59], 0
    ds_read_b64_tr_b16 v[52:53], v248 offset:10240
    v_mfma_f32_16x16x32_bf16 v[208:211], v[28:31], v[56:59], 0
    ds_read_b64_tr_b16 v[54:55], v248 offset:11520
    s_waitcnt lgkmcnt(10)
    v_mfma_f32_16x16x32_bf16 v[212:215], v[24:27], v[60:63], 0
    ds_read_b64_tr_b16 v[56:57], v249 offset:10240
    v_mfma_f32_16x16x32_bf16 v[216:219], v[28:31], v[60:63], 0
    ds_read_b64_tr_b16 v[58:59], v249 offset:11520
    s_waitcnt lgkmcnt(10)
    v_mfma_f32_16x16x32_bf16 v[220:223], v[24:27], v[40:43], 0
    ds_read_b64_tr_b16 v[60:61], v248 offset:10304
    v_mfma_f32_16x16x32_bf16 v[224:227], v[28:31], v[40:43], 0
    ds_read_b64_tr_b16 v[62:63], v248 offset:11584
    s_waitcnt lgkmcnt(10)
    v_mfma_f32_16x16x32_bf16 v[228:231], v[24:27], v[44:47], 0
    ds_read_b64_tr_b16 v[40:41], v249 offset:10304
    v_mfma_f32_16x16x32_bf16 v[232:235], v[28:31], v[44:47], 0
    ds_read_b64_tr_b16 v[42:43], v249 offset:11584
    s_waitcnt lgkmcnt(8)
    v_mfma_f32_16x16x32_bf16 v[236:239], v[24:27], v[48:51], 0
    ds_read_b64_tr_b16 v[44:45], v248 offset:10368
    v_mfma_f32_16x16x32_bf16 v[240:243], v[28:31], v[48:51], 0
    ds_read_b64_tr_b16 v[46:47], v248 offset:11648
    s_waitcnt lgkmcnt(8)
    v_mfma_f32_16x16x32_bf16 v[172:175], v[32:35], v[52:55], v[172:175]
    ds_read_b64_tr_b16 v[48:49], v249 offset:10368
    v_mfma_f32_16x16x32_bf16 v[176:179], v[36:39], v[52:55], v[176:179]
    ds_read_b64_tr_b16 v[50:51], v249 offset:11648
    s_waitcnt lgkmcnt(8)
    v_mfma_f32_16x16x32_bf16 v[180:183], v[32:35], v[56:59], v[180:183]
    ds_read_b64_tr_b16 v[52:53], v248 offset:10432
    v_mfma_f32_16x16x32_bf16 v[184:187], v[36:39], v[56:59], v[184:187]
    ds_read_b64_tr_b16 v[54:55], v248 offset:11712
    s_waitcnt lgkmcnt(8)
    v_mfma_f32_16x16x32_bf16 v[188:191], v[32:35], v[60:63], v[188:191]
    ds_read_b64_tr_b16 v[56:57], v249 offset:10432
    v_mfma_f32_16x16x32_bf16 v[192:195], v[36:39], v[60:63], v[192:195]
    ds_read_b64_tr_b16 v[58:59], v249 offset:11712
    s_barrier
    ds_read_b128 v[24:27], v244 offset:32768
    ds_read_b128 v[28:31], v244 offset:34816
    s_waitcnt lgkmcnt(10)
    v_mfma_f32_16x16x32_bf16 v[196:199], v[32:35], v[40:43], v[196:199]
    ds_read_b64_tr_b16 v[60:61], v248 offset:10496
    v_mfma_f32_16x16x32_bf16 v[200:203], v[36:39], v[40:43], v[200:203]
    ds_read_b64_tr_b16 v[62:63], v248 offset:11776
    s_waitcnt lgkmcnt(10)
    v_mfma_f32_16x16x32_bf16 v[204:207], v[32:35], v[44:47], v[204:207]
    ds_read_b64_tr_b16 v[40:41], v248 offset:20480
    v_mfma_f32_16x16x32_bf16 v[208:211], v[36:39], v[44:47], v[208:211]
    ds_read_b64_tr_b16 v[42:43], v248 offset:21760
    s_waitcnt lgkmcnt(10)
    v_mfma_f32_16x16x32_bf16 v[212:215], v[32:35], v[48:51], v[212:215]
    ds_read_b64_tr_b16 v[44:45], v249 offset:20480
    v_mfma_f32_16x16x32_bf16 v[216:219], v[36:39], v[48:51], v[216:219]
    ds_read_b64_tr_b16 v[46:47], v249 offset:21760
    s_waitcnt lgkmcnt(10)
    v_mfma_f32_16x16x32_bf16 v[220:223], v[32:35], v[52:55], v[220:223]
    ds_read_b64_tr_b16 v[48:49], v248 offset:20544
    v_mfma_f32_16x16x32_bf16 v[224:227], v[36:39], v[52:55], v[224:227]
    ds_read_b64_tr_b16 v[50:51], v248 offset:21824
    s_waitcnt lgkmcnt(10)
    v_mfma_f32_16x16x32_bf16 v[228:231], v[32:35], v[56:59], v[228:231]
    ds_read_b64_tr_b16 v[52:53], v249 offset:20544
    v_mfma_f32_16x16x32_bf16 v[232:235], v[36:39], v[56:59], v[232:235]
    ds_read_b64_tr_b16 v[54:55], v249 offset:21824
    s_waitcnt lgkmcnt(8)
    v_mfma_f32_16x16x32_bf16 v[236:239], v[32:35], v[60:63], v[236:239]
    ds_read_b64_tr_b16 v[56:57], v248 offset:20608
    v_mfma_f32_16x16x32_bf16 v[240:243], v[36:39], v[60:63], v[240:243]
    ds_read_b64_tr_b16 v[58:59], v248 offset:21888
    s_waitcnt lgkmcnt(8)
    v_mfma_f32_16x16x32_bf16 v[172:175], v[24:27], v[40:43], v[172:175]
    ds_read_b64_tr_b16 v[60:61], v249 offset:20608
    v_mfma_f32_16x16x32_bf16 v[176:179], v[28:31], v[40:43], v[176:179]
    ds_read_b64_tr_b16 v[62:63], v249 offset:21888
    s_waitcnt lgkmcnt(8)
    v_mfma_f32_16x16x32_bf16 v[180:183], v[24:27], v[44:47], v[180:183]
    ds_read_b64_tr_b16 v[40:41], v248 offset:20672
    v_mfma_f32_16x16x32_bf16 v[184:187], v[28:31], v[44:47], v[184:187]
    ds_read_b64_tr_b16 v[42:43], v248 offset:21952
    s_waitcnt lgkmcnt(8)
    v_mfma_f32_16x16x32_bf16 v[188:191], v[24:27], v[48:51], v[188:191]
    ds_read_b64_tr_b16 v[44:45], v249 offset:20672
    v_mfma_f32_16x16x32_bf16 v[192:195], v[28:31], v[48:51], v[192:195]
    ds_read_b64_tr_b16 v[46:47], v249 offset:21952
    ds_read_b128 v[32:35], v245 offset:32768
    ds_read_b128 v[36:39], v245 offset:34816
    s_waitcnt lgkmcnt(10)
    v_mfma_f32_16x16x32_bf16 v[196:199], v[24:27], v[52:55], v[196:199]
    ds_read_b64_tr_b16 v[48:49], v248 offset:20736
    v_mfma_f32_16x16x32_bf16 v[200:203], v[28:31], v[52:55], v[200:203]
    ds_read_b64_tr_b16 v[50:51], v248 offset:22016
    s_waitcnt lgkmcnt(10)
    v_mfma_f32_16x16x32_bf16 v[204:207], v[24:27], v[56:59], v[204:207]
    ds_read_b64_tr_b16 v[52:53], v248 offset:30720
    v_mfma_f32_16x16x32_bf16 v[208:211], v[28:31], v[56:59], v[208:211]
    ds_read_b64_tr_b16 v[54:55], v248 offset:32000
    s_waitcnt lgkmcnt(10)
    v_mfma_f32_16x16x32_bf16 v[212:215], v[24:27], v[60:63], v[212:215]
    ds_read_b64_tr_b16 v[56:57], v249 offset:30720
    v_mfma_f32_16x16x32_bf16 v[216:219], v[28:31], v[60:63], v[216:219]
    ds_read_b64_tr_b16 v[58:59], v249 offset:32000
    s_waitcnt lgkmcnt(10)
    v_mfma_f32_16x16x32_bf16 v[220:223], v[24:27], v[40:43], v[220:223]
    ds_read_b64_tr_b16 v[60:61], v248 offset:30784
    v_mfma_f32_16x16x32_bf16 v[224:227], v[28:31], v[40:43], v[224:227]
    ds_read_b64_tr_b16 v[62:63], v248 offset:32064
    s_waitcnt lgkmcnt(10)
    v_mfma_f32_16x16x32_bf16 v[228:231], v[24:27], v[44:47], v[228:231]
    ds_read_b64_tr_b16 v[40:41], v249 offset:30784
    v_mfma_f32_16x16x32_bf16 v[232:235], v[28:31], v[44:47], v[232:235]
    ds_read_b64_tr_b16 v[42:43], v249 offset:32064
    s_waitcnt lgkmcnt(8)
    v_mfma_f32_16x16x32_bf16 v[236:239], v[24:27], v[48:51], v[236:239]
    ds_read_b64_tr_b16 v[44:45], v248 offset:30848
    v_mfma_f32_16x16x32_bf16 v[240:243], v[28:31], v[48:51], v[240:243]
    ds_read_b64_tr_b16 v[46:47], v248 offset:32128
    s_waitcnt lgkmcnt(8)
    v_mfma_f32_16x16x32_bf16 v[172:175], v[32:35], v[52:55], v[172:175]
    ds_read_b64_tr_b16 v[48:49], v249 offset:30848
    v_mfma_f32_16x16x32_bf16 v[176:179], v[36:39], v[52:55], v[176:179]
    ds_read_b64_tr_b16 v[50:51], v249 offset:32128
    s_waitcnt lgkmcnt(8)
    v_mfma_f32_16x16x32_bf16 v[180:183], v[32:35], v[56:59], v[180:183]
    ds_read_b64_tr_b16 v[52:53], v248 offset:30912
    v_mfma_f32_16x16x32_bf16 v[184:187], v[36:39], v[56:59], v[184:187]
    ds_read_b64_tr_b16 v[54:55], v248 offset:32192
    s_waitcnt lgkmcnt(8)
    v_mfma_f32_16x16x32_bf16 v[188:191], v[32:35], v[60:63], v[188:191]
    ds_read_b64_tr_b16 v[56:57], v249 offset:30912
    v_mfma_f32_16x16x32_bf16 v[192:195], v[36:39], v[60:63], v[192:195]
    ds_read_b64_tr_b16 v[58:59], v249 offset:32192
    s_barrier
    ds_read_b128 v[24:27], v244 offset:0
    ds_read_b128 v[28:31], v244 offset:2048
    s_waitcnt lgkmcnt(10)
    v_mfma_f32_16x16x32_bf16 v[196:199], v[32:35], v[40:43], v[196:199]
    ds_read_b64_tr_b16 v[60:61], v248 offset:30976
    v_cvt_pk_bf16_f32 v136, v172, v173
    v_cvt_pk_bf16_f32 v137, v174, v175
    v_cvt_pk_bf16_f32 v138, v176, v177
    v_cvt_pk_bf16_f32 v139, v178, v179
    v_mfma_f32_16x16x32_bf16 v[200:203], v[36:39], v[40:43], v[200:203]
    ds_read_b64_tr_b16 v[62:63], v248 offset:32256
    s_waitcnt lgkmcnt(10)
    v_mfma_f32_16x16x32_bf16 v[204:207], v[32:35], v[44:47], v[204:207]
    ds_read_b64_tr_b16 v[40:41], v246 offset:0
    v_cvt_pk_bf16_f32 v140, v180, v181
    v_cvt_pk_bf16_f32 v141, v182, v183
    v_cvt_pk_bf16_f32 v142, v184, v185
    v_cvt_pk_bf16_f32 v143, v186, v187
    v_mfma_f32_16x16x32_bf16 v[208:211], v[36:39], v[44:47], v[208:211]
    ds_read_b64_tr_b16 v[42:43], v246 offset:1280
    s_waitcnt lgkmcnt(10)
    v_mfma_f32_16x16x32_bf16 v[212:215], v[32:35], v[48:51], v[212:215]
    ds_read_b64_tr_b16 v[44:45], v247 offset:0
    v_cvt_pk_bf16_f32 v144, v188, v189
    v_cvt_pk_bf16_f32 v145, v190, v191
    v_cvt_pk_bf16_f32 v146, v192, v193
    v_cvt_pk_bf16_f32 v147, v194, v195
    v_mfma_f32_16x16x32_bf16 v[216:219], v[36:39], v[48:51], v[216:219]
    ds_read_b64_tr_b16 v[46:47], v247 offset:1280
    s_waitcnt lgkmcnt(10)
    v_mfma_f32_16x16x32_bf16 v[220:223], v[32:35], v[52:55], v[220:223]
    ds_read_b64_tr_b16 v[48:49], v246 offset:64
    v_cvt_pk_bf16_f32 v148, v196, v197
    v_cvt_pk_bf16_f32 v149, v198, v199
    v_cvt_pk_bf16_f32 v150, v200, v201
    v_cvt_pk_bf16_f32 v151, v202, v203
    v_mfma_f32_16x16x32_bf16 v[224:227], v[36:39], v[52:55], v[224:227]
    ds_read_b64_tr_b16 v[50:51], v246 offset:1344
    s_waitcnt lgkmcnt(10)
    v_mfma_f32_16x16x32_bf16 v[228:231], v[32:35], v[56:59], v[228:231]
    ds_read_b64_tr_b16 v[52:53], v247 offset:64
    v_cvt_pk_bf16_f32 v152, v204, v205
    v_cvt_pk_bf16_f32 v153, v206, v207
    v_cvt_pk_bf16_f32 v154, v208, v209
    v_cvt_pk_bf16_f32 v155, v210, v211
    v_mfma_f32_16x16x32_bf16 v[232:235], v[36:39], v[56:59], v[232:235]
    ds_read_b64_tr_b16 v[54:55], v247 offset:1344
    s_waitcnt lgkmcnt(8)
    v_mfma_f32_16x16x32_bf16 v[236:239], v[32:35], v[60:63], v[236:239]
    ds_read_b64_tr_b16 v[56:57], v246 offset:128
    v_cvt_pk_bf16_f32 v156, v212, v213
    v_cvt_pk_bf16_f32 v157, v214, v215
    v_cvt_pk_bf16_f32 v158, v216, v217
    v_cvt_pk_bf16_f32 v159, v218, v219
    v_mfma_f32_16x16x32_bf16 v[240:243], v[36:39], v[60:63], v[240:243]
    ds_read_b64_tr_b16 v[58:59], v246 offset:1408
    s_waitcnt lgkmcnt(8)
    v_mfma_f32_16x16x32_bf16 v[172:175], v[24:27], v[40:43], 0
    ds_read_b64_tr_b16 v[60:61], v247 offset:128
    v_cvt_pk_bf16_f32 v160, v220, v221
    v_cvt_pk_bf16_f32 v161, v222, v223
    v_cvt_pk_bf16_f32 v162, v224, v225
    v_cvt_pk_bf16_f32 v163, v226, v227
    v_mfma_f32_16x16x32_bf16 v[176:179], v[28:31], v[40:43], 0
    ds_read_b64_tr_b16 v[62:63], v247 offset:1408
    s_mov_b32 s68, s72
    s_and_b32 s69, s73, 0xffff
    s_mov_b32 s70, 0x100
    s_mov_b32 s71, 0x00020000
    v_mov_b32 v23, 0
    buffer_load_dword v22, v23, s[68:71], 0 offen sc1
    s_waitcnt lgkmcnt(8)
    v_mfma_f32_16x16x32_bf16 v[180:183], v[24:27], v[44:47], 0
    ds_read_b64_tr_b16 v[40:41], v246 offset:192
    v_cvt_pk_bf16_f32 v164, v228, v229
    v_cvt_pk_bf16_f32 v165, v230, v231
    v_cvt_pk_bf16_f32 v166, v232, v233
    v_cvt_pk_bf16_f32 v167, v234, v235
    v_mfma_f32_16x16x32_bf16 v[184:187], v[28:31], v[44:47], 0
    ds_read_b64_tr_b16 v[42:43], v246 offset:1472
    s_waitcnt lgkmcnt(8)
    v_mfma_f32_16x16x32_bf16 v[188:191], v[24:27], v[48:51], 0
    ds_read_b64_tr_b16 v[44:45], v247 offset:192
    v_cvt_pk_bf16_f32 v168, v236, v237
    v_cvt_pk_bf16_f32 v169, v238, v239
    v_cvt_pk_bf16_f32 v170, v240, v241
    v_cvt_pk_bf16_f32 v171, v242, v243
    v_mfma_f32_16x16x32_bf16 v[192:195], v[28:31], v[48:51], 0
    ds_read_b64_tr_b16 v[46:47], v247 offset:1472
    ds_read_b128 v[32:35], v245 offset:0
    ds_read_b128 v[36:39], v245 offset:2048
    s_waitcnt lgkmcnt(10)
    v_mfma_f32_16x16x32_bf16 v[196:199], v[24:27], v[52:55], 0
    ds_read_b64_tr_b16 v[48:49], v246 offset:256
    v_mfma_f32_16x16x32_bf16 v[200:203], v[28:31], v[52:55], 0
    ds_read_b64_tr_b16 v[50:51], v246 offset:1536
    s_waitcnt lgkmcnt(10)
    v_mfma_f32_16x16x32_bf16 v[204:207], v[24:27], v[56:59], 0
    ds_read_b64_tr_b16 v[52:53], v246 offset:10240
    v_mfma_f32_16x16x32_bf16 v[208:211], v[28:31], v[56:59], 0
    ds_read_b64_tr_b16 v[54:55], v246 offset:11520
    s_waitcnt lgkmcnt(10)
    v_mfma_f32_16x16x32_bf16 v[212:215], v[24:27], v[60:63], 0
    ds_read_b64_tr_b16 v[56:57], v247 offset:10240
    v_mfma_f32_16x16x32_bf16 v[216:219], v[28:31], v[60:63], 0
    ds_read_b64_tr_b16 v[58:59], v247 offset:11520
    s_waitcnt lgkmcnt(10)
    v_mfma_f32_16x16x32_bf16 v[220:223], v[24:27], v[40:43], 0
    ds_read_b64_tr_b16 v[60:61], v246 offset:10304
    v_mfma_f32_16x16x32_bf16 v[224:227], v[28:31], v[40:43], 0
    ds_read_b64_tr_b16 v[62:63], v246 offset:11584
    s_waitcnt lgkmcnt(10)
    v_mfma_f32_16x16x32_bf16 v[228:231], v[24:27], v[44:47], 0
    ds_read_b64_tr_b16 v[40:41], v247 offset:10304
    v_mfma_f32_16x16x32_bf16 v[232:235], v[28:31], v[44:47], 0
    ds_read_b64_tr_b16 v[42:43], v247 offset:11584
    s_waitcnt lgkmcnt(8)
    v_mfma_f32_16x16x32_bf16 v[236:239], v[24:27], v[48:51], 0
    ds_read_b64_tr_b16 v[44:45], v246 offset:10368
    v_mfma_f32_16x16x32_bf16 v[240:243], v[28:31], v[48:51], 0
    ds_read_b64_tr_b16 v[46:47], v246 offset:11648
    s_waitcnt lgkmcnt(8)
    v_mfma_f32_16x16x32_bf16 v[172:175], v[32:35], v[52:55], v[172:175]
    ds_read_b64_tr_b16 v[48:49], v247 offset:10368
    v_mfma_f32_16x16x32_bf16 v[176:179], v[36:39], v[52:55], v[176:179]
    ds_read_b64_tr_b16 v[50:51], v247 offset:11648
    s_waitcnt lgkmcnt(8)
    v_mfma_f32_16x16x32_bf16 v[180:183], v[32:35], v[56:59], v[180:183]
    ds_read_b64_tr_b16 v[52:53], v246 offset:10432
    v_mfma_f32_16x16x32_bf16 v[184:187], v[36:39], v[56:59], v[184:187]
    ds_read_b64_tr_b16 v[54:55], v246 offset:11712
    s_waitcnt lgkmcnt(8)
    v_mfma_f32_16x16x32_bf16 v[188:191], v[32:35], v[60:63], v[188:191]
    ds_read_b64_tr_b16 v[56:57], v247 offset:10432
    v_mfma_f32_16x16x32_bf16 v[192:195], v[36:39], v[60:63], v[192:195]
    ds_read_b64_tr_b16 v[58:59], v247 offset:11712
    s_barrier
    ds_read_b128 v[24:27], v244 offset:16384
    ds_read_b128 v[28:31], v244 offset:18432
    s_waitcnt lgkmcnt(10)
    v_mfma_f32_16x16x32_bf16 v[196:199], v[32:35], v[40:43], v[196:199]
    ds_read_b64_tr_b16 v[60:61], v246 offset:10496
    v_mfma_f32_16x16x32_bf16 v[200:203], v[36:39], v[40:43], v[200:203]
    ds_read_b64_tr_b16 v[62:63], v246 offset:11776
    s_waitcnt lgkmcnt(10)
    v_mfma_f32_16x16x32_bf16 v[204:207], v[32:35], v[44:47], v[204:207]
    ds_read_b64_tr_b16 v[40:41], v246 offset:20480
    v_mfma_f32_16x16x32_bf16 v[208:211], v[36:39], v[44:47], v[208:211]
    ds_read_b64_tr_b16 v[42:43], v246 offset:21760
    s_waitcnt lgkmcnt(10)
    v_mfma_f32_16x16x32_bf16 v[212:215], v[32:35], v[48:51], v[212:215]
    ds_read_b64_tr_b16 v[44:45], v247 offset:20480
    v_mfma_f32_16x16x32_bf16 v[216:219], v[36:39], v[48:51], v[216:219]
    ds_read_b64_tr_b16 v[46:47], v247 offset:21760
    s_waitcnt lgkmcnt(10)
    v_mfma_f32_16x16x32_bf16 v[220:223], v[32:35], v[52:55], v[220:223]
    ds_read_b64_tr_b16 v[48:49], v246 offset:20544
    v_mfma_f32_16x16x32_bf16 v[224:227], v[36:39], v[52:55], v[224:227]
    ds_read_b64_tr_b16 v[50:51], v246 offset:21824
    s_waitcnt lgkmcnt(10)
    v_mfma_f32_16x16x32_bf16 v[228:231], v[32:35], v[56:59], v[228:231]
    ds_read_b64_tr_b16 v[52:53], v247 offset:20544
    v_mfma_f32_16x16x32_bf16 v[232:235], v[36:39], v[56:59], v[232:235]
    ds_read_b64_tr_b16 v[54:55], v247 offset:21824
    s_waitcnt lgkmcnt(8)
    v_mfma_f32_16x16x32_bf16 v[236:239], v[32:35], v[60:63], v[236:239]
    ds_read_b64_tr_b16 v[56:57], v246 offset:20608
    v_mfma_f32_16x16x32_bf16 v[240:243], v[36:39], v[60:63], v[240:243]
    ds_read_b64_tr_b16 v[58:59], v246 offset:21888
    s_waitcnt lgkmcnt(8)
    v_mfma_f32_16x16x32_bf16 v[172:175], v[24:27], v[40:43], v[172:175]
    ds_read_b64_tr_b16 v[60:61], v247 offset:20608
    v_mfma_f32_16x16x32_bf16 v[176:179], v[28:31], v[40:43], v[176:179]
    ds_read_b64_tr_b16 v[62:63], v247 offset:21888
    s_waitcnt lgkmcnt(8)
    v_mfma_f32_16x16x32_bf16 v[180:183], v[24:27], v[44:47], v[180:183]
    ds_read_b64_tr_b16 v[40:41], v246 offset:20672
    v_mfma_f32_16x16x32_bf16 v[184:187], v[28:31], v[44:47], v[184:187]
    ds_read_b64_tr_b16 v[42:43], v246 offset:21952
    s_waitcnt lgkmcnt(8)
    v_mfma_f32_16x16x32_bf16 v[188:191], v[24:27], v[48:51], v[188:191]
    ds_read_b64_tr_b16 v[44:45], v247 offset:20672
    v_mfma_f32_16x16x32_bf16 v[192:195], v[28:31], v[48:51], v[192:195]
    ds_read_b64_tr_b16 v[46:47], v247 offset:21952
    ds_read_b128 v[32:35], v245 offset:16384
    ds_read_b128 v[36:39], v245 offset:18432
    s_waitcnt lgkmcnt(10)
    v_mfma_f32_16x16x32_bf16 v[196:199], v[24:27], v[52:55], v[196:199]
    ds_read_b64_tr_b16 v[48:49], v246 offset:20736
    v_mfma_f32_16x16x32_bf16 v[200:203], v[28:31], v[52:55], v[200:203]
    ds_read_b64_tr_b16 v[50:51], v246 offset:22016
    s_waitcnt lgkmcnt(10)
    v_mfma_f32_16x16x32_bf16 v[204:207], v[24:27], v[56:59], v[204:207]
    ds_read_b64_tr_b16 v[52:53], v246 offset:30720
    v_mfma_f32_16x16x32_bf16 v[208:211], v[28:31], v[56:59], v[208:211]
    ds_read_b64_tr_b16 v[54:55], v246 offset:32000
    s_waitcnt lgkmcnt(10)
    v_mfma_f32_16x16x32_bf16 v[212:215], v[24:27], v[60:63], v[212:215]
    ds_read_b64_tr_b16 v[56:57], v247 offset:30720
    v_mfma_f32_16x16x32_bf16 v[216:219], v[28:31], v[60:63], v[216:219]
    ds_read_b64_tr_b16 v[58:59], v247 offset:32000
    s_waitcnt lgkmcnt(10)
    v_mfma_f32_16x16x32_bf16 v[220:223], v[24:27], v[40:43], v[220:223]
    ds_read_b64_tr_b16 v[60:61], v246 offset:30784
    v_mfma_f32_16x16x32_bf16 v[224:227], v[28:31], v[40:43], v[224:227]
    ds_read_b64_tr_b16 v[62:63], v246 offset:32064
    s_waitcnt lgkmcnt(10)
    v_mfma_f32_16x16x32_bf16 v[228:231], v[24:27], v[44:47], v[228:231]
    ds_read_b64_tr_b16 v[40:41], v247 offset:30784
    v_mfma_f32_16x16x32_bf16 v[232:235], v[28:31], v[44:47], v[232:235]
    ds_read_b64_tr_b16 v[42:43], v247 offset:32064
    s_waitcnt lgkmcnt(8)
    v_mfma_f32_16x16x32_bf16 v[236:239], v[24:27], v[48:51], v[236:239]
    ds_read_b64_tr_b16 v[44:45], v246 offset:30848
    v_mfma_f32_16x16x32_bf16 v[240:243], v[28:31], v[48:51], v[240:243]
    ds_read_b64_tr_b16 v[46:47], v246 offset:32128
    s_waitcnt lgkmcnt(8)
    v_mfma_f32_16x16x32_bf16 v[172:175], v[32:35], v[52:55], v[172:175]
    ds_read_b64_tr_b16 v[48:49], v247 offset:30848
    v_mfma_f32_16x16x32_bf16 v[176:179], v[36:39], v[52:55], v[176:179]
    ds_read_b64_tr_b16 v[50:51], v247 offset:32128
    s_waitcnt lgkmcnt(8)
    v_mfma_f32_16x16x32_bf16 v[180:183], v[32:35], v[56:59], v[180:183]
    ds_read_b64_tr_b16 v[52:53], v246 offset:30912
    v_mfma_f32_16x16x32_bf16 v[184:187], v[36:39], v[56:59], v[184:187]
    ds_read_b64_tr_b16 v[54:55], v246 offset:32192
    s_waitcnt lgkmcnt(8)
    v_mfma_f32_16x16x32_bf16 v[188:191], v[32:35], v[60:63], v[188:191]
    ds_read_b64_tr_b16 v[56:57], v247 offset:30912
    v_mfma_f32_16x16x32_bf16 v[192:195], v[36:39], v[60:63], v[192:195]
    ds_read_b64_tr_b16 v[58:59], v247 offset:32192
    s_waitcnt lgkmcnt(8)
    v_mfma_f32_16x16x32_bf16 v[196:199], v[32:35], v[40:43], v[196:199]
    ds_read_b64_tr_b16 v[60:61], v246 offset:30976
    v_cvt_pk_bf16_f32 v172, v172, v173
    v_cvt_pk_bf16_f32 v173, v174, v175
    v_cvt_pk_bf16_f32 v174, v176, v177
    v_cvt_pk_bf16_f32 v175, v178, v179
    v_mfma_f32_16x16x32_bf16 v[200:203], v[36:39], v[40:43], v[200:203]
    ds_read_b64_tr_b16 v[62:63], v246 offset:32256
    s_waitcnt lgkmcnt(8)
    v_mfma_f32_16x16x32_bf16 v[204:207], v[32:35], v[44:47], v[204:207]
    v_cvt_pk_bf16_f32 v176, v180, v181
    v_cvt_pk_bf16_f32 v177, v182, v183
    v_cvt_pk_bf16_f32 v178, v184, v185
    v_cvt_pk_bf16_f32 v179, v186, v187
    v_mfma_f32_16x16x32_bf16 v[208:211], v[36:39], v[44:47], v[208:211]
    s_waitcnt lgkmcnt(6)
    v_mfma_f32_16x16x32_bf16 v[212:215], v[32:35], v[48:51], v[212:215]
    v_cvt_pk_bf16_f32 v180, v188, v189
    v_cvt_pk_bf16_f32 v181, v190, v191
    v_cvt_pk_bf16_f32 v182, v192, v193
    v_cvt_pk_bf16_f32 v183, v194, v195
    v_mfma_f32_16x16x32_bf16 v[216:219], v[36:39], v[48:51], v[216:219]
    s_waitcnt lgkmcnt(4)
    v_mfma_f32_16x16x32_bf16 v[220:223], v[32:35], v[52:55], v[220:223]
    v_cvt_pk_bf16_f32 v184, v196, v197
    v_cvt_pk_bf16_f32 v185, v198, v199
    v_cvt_pk_bf16_f32 v186, v200, v201
    v_cvt_pk_bf16_f32 v187, v202, v203
    v_mfma_f32_16x16x32_bf16 v[224:227], v[36:39], v[52:55], v[224:227]
    s_waitcnt lgkmcnt(2)
    v_mfma_f32_16x16x32_bf16 v[228:231], v[32:35], v[56:59], v[228:231]
    v_cvt_pk_bf16_f32 v188, v204, v205
    v_cvt_pk_bf16_f32 v189, v206, v207
    v_cvt_pk_bf16_f32 v190, v208, v209
    v_cvt_pk_bf16_f32 v191, v210, v211
    v_mfma_f32_16x16x32_bf16 v[232:235], v[36:39], v[56:59], v[232:235]
    s_waitcnt lgkmcnt(0)
    v_mfma_f32_16x16x32_bf16 v[236:239], v[32:35], v[60:63], v[236:239]
    v_cvt_pk_bf16_f32 v192, v212, v213
    v_cvt_pk_bf16_f32 v193, v214, v215
    v_cvt_pk_bf16_f32 v194, v216, v217
    v_cvt_pk_bf16_f32 v195, v218, v219
    v_mfma_f32_16x16x32_bf16 v[240:243], v[36:39], v[60:63], v[240:243]
    s_lshl_b32 s58, s18, 2
    s_add_u32 s58, s58, s19
    s_lshl_b32 s58, s58, 2
    s_add_u32 s58, s58, s12
    s_lshl_b32 s60, s58, 3
    s_add_u32 s60, s60, s13
    s_lshl_b32 s60, s60, 6
    s_add_u32 s60, s60, 264765440
    s_mul_i32 s58, s58, 73728
    s_lshl_b32 s59, s13, 10
    s_add_u32 s58, s58, s59
    s_add_u32 s58, s58, 253755392
    v_lshlrev_b32 v11, 4, v2
    v_add_u32 v11, s58, v11
    s_mov_b32 s36, s14
    s_and_b32 s37, s15, 0xffff
    s_mov_b32 s38, 0x10000000
    s_mov_b32 s39, 0x00020000
    v_bfe_u32 v16, v2, 4, 1
    v_lshlrev_b32 v16, 3, v16
    v_bfe_u32 v17, v2, 5, 1
    v_lshlrev_b32 v17, 2, v17
    v_add_u32 v16, v16, v17
    v_add_u32 v16, s60, v16
    v_lshlrev_b32 v20, 1, v2
    v_or_b32 v20, 1, v20
    s_mov_b32 s61, 0x9E3779B1
    v_mul_lo_u32 v20, v20, s61
    s_and_b32 s58, s13, 1
    s_cmp_eq_u32 s58, 1
    s_cselect_b32 s57, 0x1e0, 0x1f
    s_lshr_b32 s58, s13, 1
    s_cmp_eq_u32 s58, s12
    s_cselect_b32 s57, s57, 0
    v_lshlrev_b32 v19, 4, v2
    v_cvt_pk_bf16_f32 v196, v220, v221
    v_cvt_pk_bf16_f32 v197, v222, v223
    v_cvt_pk_bf16_f32 v198, v224, v225
    v_cvt_pk_bf16_f32 v199, v226, v227
    v_cvt_pk_bf16_f32 v200, v228, v229
    v_cvt_pk_bf16_f32 v201, v230, v231
    v_cvt_pk_bf16_f32 v202, v232, v233
    v_cvt_pk_bf16_f32 v203, v234, v235
    v_cvt_pk_bf16_f32 v204, v236, v237
    v_cvt_pk_bf16_f32 v205, v238, v239
    v_cvt_pk_bf16_f32 v206, v240, v241
    v_cvt_pk_bf16_f32 v207, v242, v243
    s_waitcnt vmcnt(0)
L_nonce_5:
    v_readfirstlane_b32 s74, v22
    s_nop 3
    s_cmp_lg_u32 s74, 0
    s_cbranch_scc1 L_nonce_ok_6
    buffer_load_dword v22, v23, s[68:71], 0 offen sc1
    s_waitcnt vmcnt(0)
    s_branch L_nonce_5
L_nonce_ok_6:
    s_barrier
    s_add_u32 s58, s62, 0
    s_and_b32 s58, s58, 3
    s_lshl_b32 s58, s58, 11
    v_add_u32 v251, s58, v250
    ds_read_b128 v[208:211], v251 offset:0
    ds_read_b128 v[212:215], v251 offset:1024
    s_add_u32 s58, s62, 1
    s_and_b32 s58, s58, 3
    s_lshl_b32 s58, s58, 11
    v_add_u32 v251, s58, v250
    ds_read_b128 v[216:219], v251 offset:0
    ds_read_b128 v[220:223], v251 offset:1024
    s_add_u32 s58, s62, 2
    s_and_b32 s58, s58, 3
    s_lshl_b32 s58, s58, 11
    v_add_u32 v251, s58, v250
    ds_read_b128 v[224:227], v251 offset:0
    ds_read_b128 v[228:231], v251 offset:1024
    s_add_u32 s58, s62, 3
    s_and_b32 s58, s58, 3
    s_lshl_b32 s58, s58, 11
    v_add_u32 v251, s58, v250
    ds_read_b128 v[232:235], v251 offset:0
    ds_read_b128 v[236:239], v251 offset:1024
    v_mov_b32 v249, 0
    v_mov_b32 v250, 0
    v_mov_b32 v251, 0
    s_waitcnt lgkmcnt(7)
    v_mfma_f32_16x16x32_bf16 v[40:43], v[64:67], v[208:211], 0
    s_waitcnt lgkmcnt(6)
    v_mfma_f32_16x16x32_bf16 v[44:47], v[64:67], v[212:215], 0
    s_waitcnt lgkmcnt(5)
    v_mfma_f32_16x16x32_bf16 v[40:43], v[100:103], v[216:219], v[40:43]
    s_waitcnt lgkmcnt(4)
    v_mfma_f32_16x16x32_bf16 v[44:47], v[100:103], v[220:223], v[44:47]
    s_waitcnt lgkmcnt(3)
    v_mfma_f32_16x16x32_bf16 v[40:43], v[136:139], v[224:227], v[40:43]
    s_waitcnt lgkmcnt(2)
    v_mfma_f32_16x16x32_bf16 v[44:47], v[136:139], v[228:231], v[44:47]
    s_waitcnt lgkmcnt(1)
    v_mfma_f32_16x16x32_bf16 v[40:43], v[172:175], v[232:235], v[40:43]
    s_waitcnt lgkmcnt(0)
    v_mfma_f32_16x16x32_bf16 v[44:47], v[172:175], v[236:239], v[44:47]
    v_mfma_f32_16x16x32_bf16 v[48:51], v[68:71], v[208:211], 0
    v_mfma_f32_16x16x32_bf16 v[52:55], v[68:71], v[212:215], 0
    v_mfma_f32_16x16x32_bf16 v[48:51], v[104:107], v[216:219], v[48:51]
    v_mfma_f32_16x16x32_bf16 v[52:55], v[104:107], v[220:223], v[52:55]
    v_mfma_f32_16x16x32_bf16 v[48:51], v[140:143], v[224:227], v[48:51]
    v_mfma_f32_16x16x32_bf16 v[52:55], v[140:143], v[228:231], v[52:55]
    v_mfma_f32_16x16x32_bf16 v[48:51], v[176:179], v[232:235], v[48:51]
    v_mfma_f32_16x16x32_bf16 v[52:55], v[176:179], v[236:239], v[52:55]
    v_cvt_pk_bf16_f32 v24, v40, v41
    v_cvt_pk_bf16_f32 v25, v42, v43
    v_cvt_pk_bf16_f32 v26, v44, v45
    v_cvt_pk_bf16_f32 v27, v46, v47
    s_bitcmp1_b32 s57, 0
    s_cbranch_scc1 L_own_7
    s_mov_b32 s50, 0
    buffer_store_dwordx4 v[24:27], v11, s[36:39], s50 offen sc1
    s_branch L_ownc_8
L_own_7:
    ds_write_b128 v19, v[24:27] offset:0
L_ownc_8:
    v_alignbit_b32 v21, v25, v25, 25
    v_alignbit_b32 v7, v26, v26, 19
    v_add3_u32 v240, v24, v21, v7
    v_alignbit_b32 v21, v27, v27, 9
    v_add_u32 v240, v240, v21
    v_mul_lo_u32 v240, v240, v20
    v_lshrrev_b32 v21, 16, v240
    v_xor_b32 v240, v240, v21
    v_mfma_f32_16x16x32_bf16 v[56:59], v[72:75], v[208:211], 0
    v_mfma_f32_16x16x32_bf16 v[60:63], v[72:75], v[212:215], 0
    v_mfma_f32_16x16x32_bf16 v[56:59], v[108:111], v[216:219], v[56:59]
    v_mfma_f32_16x16x32_bf16 v[60:63], v[108:111], v[220:223], v[60:63]
    v_mfma_f32_16x16x32_bf16 v[56:59], v[144:147], v[224:227], v[56:59]
    v_mfma_f32_16x16x32_bf16 v[60:63], v[144:147], v[228:231], v[60:63]
    v_mfma_f32_16x16x32_bf16 v[56:59], v[180:183], v[232:235], v[56:59]
    v_mfma_f32_16x16x32_bf16 v[60:63], v[180:183], v[236:239], v[60:63]
    v_cvt_pk_bf16_f32 v28, v48, v49
    v_cvt_pk_bf16_f32 v29, v50, v51
    v_cvt_pk_bf16_f32 v30, v52, v53
    v_cvt_pk_bf16_f32 v31, v54, v55
    s_bitcmp1_b32 s57, 1
    s_cbranch_scc1 L_own_9
    s_mov_b32 s50, 8192
    buffer_store_dwordx4 v[28:31], v11, s[36:39], s50 offen sc1
    s_branch L_ownc_10
L_own_9:
    ds_write_b128 v19, v[28:31] offset:1024
L_ownc_10:
    v_alignbit_b32 v21, v29, v29, 25
    v_alignbit_b32 v7, v30, v30, 19
    v_add3_u32 v241, v28, v21, v7
    v_alignbit_b32 v21, v31, v31, 9
    v_add_u32 v241, v241, v21
    v_mul_lo_u32 v241, v241, v20
    v_lshrrev_b32 v21, 16, v241
    v_xor_b32 v241, v241, v21
    v_mfma_f32_16x16x32_bf16 v[40:43], v[76:79], v[208:211], 0
    v_mfma_f32_16x16x32_bf16 v[44:47], v[76:79], v[212:215], 0
    v_mfma_f32_16x16x32_bf16 v[40:43], v[112:115], v[216:219], v[40:43]
    v_mfma_f32_16x16x32_bf16 v[44:47], v[112:115], v[220:223], v[44:47]
    v_mfma_f32_16x16x32_bf16 v[40:43], v[148:151], v[224:227], v[40:43]
    v_mfma_f32_16x16x32_bf16 v[44:47], v[148:151], v[228:231], v[44:47]
    v_mfma_f32_16x16x32_bf16 v[40:43], v[184:187], v[232:235], v[40:43]
    v_mfma_f32_16x16x32_bf16 v[44:47], v[184:187], v[236:239], v[44:47]
    v_cvt_pk_bf16_f32 v32, v56, v57
    v_cvt_pk_bf16_f32 v33, v58, v59
    v_cvt_pk_bf16_f32 v34, v60, v61
    v_cvt_pk_bf16_f32 v35, v62, v63
    s_bitcmp1_b32 s57, 2
    s_cbranch_scc1 L_own_11
    s_mov_b32 s50, 16384
    buffer_store_dwordx4 v[32:35], v11, s[36:39], s50 offen sc1
    s_branch L_ownc_12
L_own_11:
    ds_write_b128 v19, v[32:35] offset:2048
L_ownc_12:
    v_alignbit_b32 v21, v33, v33, 25
    v_alignbit_b32 v7, v34, v34, 19
    v_add3_u32 v242, v32, v21, v7
    v_alignbit_b32 v21, v35, v35, 9
    v_add_u32 v242, v242, v21
    v_mul_lo_u32 v242, v242, v20
    v_lshrrev_b32 v21, 16, v242
    v_xor_b32 v242, v242, v21
    v_mfma_f32_16x16x32_bf16 v[48:51], v[80:83], v[208:211], 0
    v_mfma_f32_16x16x32_bf16 v[52:55], v[80:83], v[212:215], 0
    v_mfma_f32_16x16x32_bf16 v[48:51], v[116:119], v[216:219], v[48:51]
    v_mfma_f32_16x16x32_bf16 v[52:55], v[116:119], v[220:223], v[52:55]
    v_mfma_f32_16x16x32_bf16 v[48:51], v[152:155], v[224:227], v[48:51]
    v_mfma_f32_16x16x32_bf16 v[52:55], v[152:155], v[228:231], v[52:55]
    v_mfma_f32_16x16x32_bf16 v[48:51], v[188:191], v[232:235], v[48:51]
    v_mfma_f32_16x16x32_bf16 v[52:55], v[188:191], v[236:239], v[52:55]
    v_cvt_pk_bf16_f32 v36, v40, v41
    v_cvt_pk_bf16_f32 v37, v42, v43
    v_cvt_pk_bf16_f32 v38, v44, v45
    v_cvt_pk_bf16_f32 v39, v46, v47
    s_bitcmp1_b32 s57, 3
    s_cbranch_scc1 L_own_13
    s_mov_b32 s50, 24576
    buffer_store_dwordx4 v[36:39], v11, s[36:39], s50 offen sc1
    s_branch L_ownc_14
L_own_13:
    ds_write_b128 v19, v[36:39] offset:3072
L_ownc_14:
    v_alignbit_b32 v21, v37, v37, 25
    v_alignbit_b32 v7, v38, v38, 19
    v_add3_u32 v243, v36, v21, v7
    v_alignbit_b32 v21, v39, v39, 9
    v_add_u32 v243, v243, v21
    v_mul_lo_u32 v243, v243, v20
    v_lshrrev_b32 v21, 16, v243
    v_xor_b32 v243, v243, v21
    v_mfma_f32_16x16x32_bf16 v[56:59], v[84:87], v[208:211], 0
    v_mfma_f32_16x16x32_bf16 v[60:63], v[84:87], v[212:215], 0
    v_mfma_f32_16x16x32_bf16 v[56:59], v[120:123], v[216:219], v[56:59]
    v_mfma_f32_16x16x32_bf16 v[60:63], v[120:123], v[220:223], v[60:63]
    v_mfma_f32_16x16x32_bf16 v[56:59], v[156:159], v[224:227], v[56:59]
    v_mfma_f32_16x16x32_bf16 v[60:63], v[156:159], v[228:231], v[60:63]
    v_mfma_f32_16x16x32_bf16 v[56:59], v[192:195], v[232:235], v[56:59]
    v_mfma_f32_16x16x32_bf16 v[60:63], v[192:195], v[236:239], v[60:63]
    v_cvt_pk_bf16_f32 v24, v48, v49
    v_cvt_pk_bf16_f32 v25, v50, v51
    v_cvt_pk_bf16_f32 v26, v52, v53
    v_cvt_pk_bf16_f32 v27, v54, v55
    s_bitcmp1_b32 s57, 4
    s_cbranch_scc1 L_own_15
    s_mov_b32 s50, 32768
    buffer_store_dwordx4 v[24:27], v11, s[36:39], s50 offen sc1
    s_branch L_ownc_16
L_own_15:
    ds_write_b128 v19, v[24:27] offset:4096
L_ownc_16:
    v_alignbit_b32 v21, v25, v25, 25
    v_alignbit_b32 v7, v26, v26, 19
    v_add3_u32 v244, v24, v21, v7
    v_alignbit_b32 v21, v27, v27, 9
    v_add_u32 v244, v244, v21
    v_mul_lo_u32 v244, v244, v20
    v_lshrrev_b32 v21, 16, v244
    v_xor_b32 v244, v244, v21
    s_nop 1
    v_permlane32_swap_b32 v240, v241
    v_permlane32_swap_b32 v242, v243
    s_nop 1
    v_xor_b32 v240, v240, v241
    v_xor_b32 v242, v242, v243
    s_nop 1
    v_permlane16_swap_b32 v240, v242
    s_nop 1
    v_xor_b32 v240, v240, v242
    s_nop 1
    v_xor_b32_dpp v240, v240, v240 row_ror:8 row_mask:0xf bank_mask:0xf
    s_nop 1
    v_xor_b32_dpp v240, v240, v240 row_ror:4 row_mask:0xf bank_mask:0xf
    s_nop 1
    v_xor_b32_dpp v240, v240, v240 row_ror:2 row_mask:0xf bank_mask:0xf
    s_nop 1
    v_xor_b32_dpp v240, v240, v240 row_ror:1 row_mask:0xf bank_mask:0xf
    v_xor_b32 v240, s74, v240
    s_mov_b32 s76, 0x00010001
    s_mov_b32 s77, 0x00010001
    s_mov_b64 exec, s[76:77]
    buffer_store_dword v240, v16, s[36:39], 0 offen offset:0 sc1
    s_mov_b64 exec, -1
    s_nop 3
    v_mfma_f32_16x16x32_bf16 v[40:43], v[88:91], v[208:211], 0
    v_mfma_f32_16x16x32_bf16 v[44:47], v[88:91], v[212:215], 0
    v_mfma_f32_16x16x32_bf16 v[40:43], v[124:127], v[216:219], v[40:43]
    v_mfma_f32_16x16x32_bf16 v[44:47], v[124:127], v[220:223], v[44:47]
    v_mfma_f32_16x16x32_bf16 v[40:43], v[160:163], v[224:227], v[40:43]
    v_mfma_f32_16x16x32_bf16 v[44:47], v[160:163], v[228:231], v[44:47]
    v_mfma_f32_16x16x32_bf16 v[40:43], v[196:199], v[232:235], v[40:43]
    v_mfma_f32_16x16x32_bf16 v[44:47], v[196:199], v[236:239], v[44:47]
    v_cvt_pk_bf16_f32 v28, v56, v57
    v_cvt_pk_bf16_f32 v29, v58, v59
    v_cvt_pk_bf16_f32 v30, v60, v61
    v_cvt_pk_bf16_f32 v31, v62, v63
    s_bitcmp1_b32 s57, 5
    s_cbranch_scc1 L_own_17
    s_mov_b32 s50, 40960
    buffer_store_dwordx4 v[28:31], v11, s[36:39], s50 offen sc1
    s_branch L_ownc_18
L_own_17:
    ds_write_b128 v19, v[28:31] offset:5120
L_ownc_18:
    v_alignbit_b32 v21, v29, v29, 25
    v_alignbit_b32 v7, v30, v30, 19
    v_add3_u32 v245, v28, v21, v7
    v_alignbit_b32 v21, v31, v31, 9
    v_add_u32 v245, v245, v21
    v_mul_lo_u32 v245, v245, v20
    v_lshrrev_b32 v21, 16, v245
    v_xor_b32 v245, v245, v21
    s_nop 1
    v_permlane32_swap_b32 v244, v249
    v_permlane32_swap_b32 v250, v251
    s_nop 1
    v_xor_b32 v244, v244, v249
    v_xor_b32 v250, v250, v251
    s_nop 1
    v_permlane16_swap_b32 v244, v250
    s_nop 1
    v_xor_b32 v244, v244, v250
    s_nop 1
    v_xor_b32_dpp v244, v244, v244 row_ror:8 row_mask:0xf bank_mask:0xf
    s_nop 1
    v_xor_b32_dpp v244, v244, v244 row_ror:4 row_mask:0xf bank_mask:0xf
    s_nop 1
    v_xor_b32_dpp v244, v244, v244 row_ror:2 row_mask:0xf bank_mask:0xf
    s_nop 1
    v_xor_b32_dpp v244, v244, v244 row_ror:1 row_mask:0xf bank_mask:0xf
    v_xor_b32 v244, s74, v244
    s_mov_b64 exec, 1
    buffer_store_dword v244, v16, s[36:39], 0 offen offset:16 sc1
    s_mov_b64 exec, -1
    s_nop 3
    v_mfma_f32_16x16x32_bf16 v[48:51], v[92:95], v[208:211], 0
    v_mfma_f32_16x16x32_bf16 v[52:55], v[92:95], v[212:215], 0
    v_mfma_f32_16x16x32_bf16 v[48:51], v[128:131], v[216:219], v[48:51]
    v_mfma_f32_16x16x32_bf16 v[52:55], v[128:131], v[220:223], v[52:55]
    v_mfma_f32_16x16x32_bf16 v[48:51], v[164:167], v[224:227], v[48:51]
    v_mfma_f32_16x16x32_bf16 v[52:55], v[164:167], v[228:231], v[52:55]
    v_mfma_f32_16x16x32_bf16 v[48:51], v[200:203], v[232:235], v[48:51]
    v_mfma_f32_16x16x32_bf16 v[52:55], v[200:203], v[236:239], v[52:55]
    v_cvt_pk_bf16_f32 v32, v40, v41
    v_cvt_pk_bf16_f32 v33, v42, v43
    v_cvt_pk_bf16_f32 v34, v44, v45
    v_cvt_pk_bf16_f32 v35, v46, v47
    s_bitcmp1_b32 s57, 6
    s_cbranch_scc1 L_own_19
    s_mov_b32 s50, 49152
    buffer_store_dwordx4 v[32:35], v11, s[36:39], s50 offen sc1
    s_branch L_ownc_20
L_own_19:
    ds_write_b128 v19, v[32:35] offset:6144
L_ownc_20:
    v_alignbit_b32 v21, v33, v33, 25
    v_alignbit_b32 v7, v34, v34, 19
    v_add3_u32 v246, v32, v21, v7
    v_alignbit_b32 v21, v35, v35, 9
    v_add_u32 v246, v246, v21
    v_mul_lo_u32 v246, v246, v20
    v_lshrrev_b32 v21, 16, v246
    v_xor_b32 v246, v246, v21
    v_mfma_f32_16x16x32_bf16 v[56:59], v[96:99], v[208:211], 0
    v_mfma_f32_16x16x32_bf16 v[60:63], v[96:99], v[212:215], 0
    v_mfma_f32_16x16x32_bf16 v[56:59], v[132:135], v[216:219], v[56:59]
    v_mfma_f32_16x16x32_bf16 v[60:63], v[132:135], v[220:223], v[60:63]
    v_mfma_f32_16x16x32_bf16 v[56:59], v[168:171], v[224:227], v[56:59]
    v_mfma_f32_16x16x32_bf16 v[60:63], v[168:171], v[228:231], v[60:63]
    v_mfma_f32_16x16x32_bf16 v[56:59], v[204:207], v[232:235], v[56:59]
    v_mfma_f32_16x16x32_bf16 v[60:63], v[204:207], v[236:239], v[60:63]
    v_cvt_pk_bf16_f32 v36, v48, v49
    v_cvt_pk_bf16_f32 v37, v50, v51
    v_cvt_pk_bf16_f32 v38, v52, v53
    v_cvt_pk_bf16_f32 v39, v54, v55
    s_bitcmp1_b32 s57, 7
    s_cbranch_scc1 L_own_21
    s_mov_b32 s50, 57344
    buffer_store_dwordx4 v[36:39], v11, s[36:39], s50 offen sc1
    s_branch L_ownc_22
L_own_21:
    ds_write_b128 v19, v[36:39] offset:7168
L_ownc_22:
    v_alignbit_b32 v21, v37, v37, 25
    v_alignbit_b32 v7, v38, v38, 19
    v_add3_u32 v247, v36, v21, v7
    v_alignbit_b32 v21, v39, v39, 9
    v_add_u32 v247, v247, v21
    v_mul_lo_u32 v247, v247, v20
    v_lshrrev_b32 v21, 16, v247
    v_xor_b32 v247, v247, v21
    s_nop 7
    v_cvt_pk_bf16_f32 v24, v56, v57
    v_cvt_pk_bf16_f32 v25, v58, v59
    v_cvt_pk_bf16_f32 v26, v60, v61
    v_cvt_pk_bf16_f32 v27, v62, v63
    s_bitcmp1_b32 s57, 8
    s_cbranch_scc1 L_own_23
    s_mov_b32 s50, 65536
    buffer_store_dwordx4 v[24:27], v11, s[36:39], s50 offen sc1
    s_branch L_ownc_24
L_own_23:
    ds_write_b128 v19, v[24:27] offset:8192
L_ownc_24:
    v_alignbit_b32 v21, v25, v25, 25
    v_alignbit_b32 v7, v26, v26, 19
    v_add3_u32 v248, v24, v21, v7
    v_alignbit_b32 v21, v27, v27, 9
    v_add_u32 v248, v248, v21
    v_mul_lo_u32 v248, v248, v20
    v_lshrrev_b32 v21, 16, v248
    v_xor_b32 v248, v248, v21
    s_nop 1
    v_permlane32_swap_b32 v245, v246
    v_permlane32_swap_b32 v247, v248
    s_nop 1
    v_xor_b32 v245, v245, v246
    v_xor_b32 v247, v247, v248
    s_nop 1
    v_permlane16_swap_b32 v245, v247
    s_nop 1
    v_xor_b32 v245, v245, v247
    s_nop 1
    v_xor_b32_dpp v245, v245, v245 row_ror:8 row_mask:0xf bank_mask:0xf
    s_nop 1
    v_xor_b32_dpp v245, v245, v245 row_ror:4 row_mask:0xf bank_mask:0xf
    s_nop 1
    v_xor_b32_dpp v245, v245, v245 row_ror:2 row_mask:0xf bank_mask:0xf
    s_nop 1
    v_xor_b32_dpp v245, v245, v245 row_ror:1 row_mask:0xf bank_mask:0xf
    v_xor_b32 v245, s74, v245
    s_mov_b32 s76, 0x00010001
    s_mov_b32 s77, 0x00010001
    s_mov_b64 exec, s[76:77]
    buffer_store_dword v245, v16, s[36:39], 0 offen offset:20 sc1
    s_mov_b64 exec, -1
    s_nop 3
    s_and_b32 s58, s13, 1
    s_mul_i32 s58, s58, 5
    s_add_u32 s21, s58, s12
    s_lshr_b32 s22, s13, 1
    s_lshl_b32 s23, s18, 2
    s_add_u32 s23, s23, s19
    s_lshl_b32 s23, s23, 2
    s_add_u32 s23, s23, s22
    s_mul_i32 s20, s23, 9
    s_add_u32 s20, s20, s21
    s_lshl_b32 s58, s20, 13
    s_add_u32 s58, s58, 253755392
    v_lshlrev_b32 v3, 4, v2
    v_add_u32 v3, s58, v3
    s_lshl_b32 s58, s23, 9
    s_lshl_b32 s59, s21, 2
    s_add_u32 s58, s58, s59
    s_add_u32 s58, s58, 264765440
    v_bfe_u32 v6, v2, 4, 1
    v_lshlrev_b32 v6, 7, v6
    v_bfe_u32 v7, v2, 5, 1
    v_lshlrev_b32 v7, 6, v7
    v_add_u32 v6, v6, v7
    v_add_u32 v6, s58, v6
    v_lshlrev_b32 v108, 1, v2
    v_or_b32 v108, 1, v108
    s_mov_b32 s61, 0x9E3779B1
    v_mul_lo_u32 v108, v108, s61
    s_lshl_b32 s58, s21, 10
    v_lshlrev_b32 v7, 4, v2
    v_add_u32 v7, s58, v7
    s_load_dwordx2 s[6:7], s[0:1], 40
    s_lshl_b32 s59, s18, 7
    s_lshl_b32 s61, s22, 5
    s_add_u32 s59, s59, s61
    s_mul_i32 s59, s59, 1152
    s_mul_i32 s63, s19, 288
    s_lshl_b32 s60, s21, 5
    s_add_u32 s59, s59, s63
    s_add_u32 s59, s59, s60
    v_and_b32 v4, 15, v2
    s_movk_i32 s45, 1152
    v_mul_lo_u32 v4, v4, s45
    v_lshrrev_b32 v5, 4, v2
    v_lshlrev_b32 v5, 3, v5
    v_add_u32 v4, v4, v5
    v_add_u32 v4, s59, v4
    s_waitcnt vmcnt(0) lgkmcnt(0)
    s_barrier
L_retry_27:
    s_cmp_eq_u32 s13, 0
    s_cbranch_scc1 L_rown_29
    s_mov_b32 s50, 0
    buffer_load_dwordx4 v[64:67], v3, s[36:39], s50 offen sc1
    s_branch L_rownc_30
L_rown_29:
    ds_read_b128 v[64:67], v7
L_rownc_30:
    s_cmp_eq_u32 s13, 1
    s_cbranch_scc1 L_rown_31
    s_mov_b32 s50, 1024
    buffer_load_dwordx4 v[68:71], v3, s[36:39], s50 offen sc1
    s_branch L_rownc_32
L_rown_31:
    ds_read_b128 v[68:71], v7
L_rownc_32:
    s_cmp_eq_u32 s13, 2
    s_cbranch_scc1 L_rown_33
    s_mov_b32 s50, 2048
    buffer_load_dwordx4 v[72:75], v3, s[36:39], s50 offen sc1
    s_branch L_rownc_34
L_rown_33:
    ds_read_b128 v[72:75], v7
L_rownc_34:
    s_cmp_eq_u32 s13, 3
    s_cbranch_scc1 L_rown_35
    s_mov_b32 s50, 3072
    buffer_load_dwordx4 v[76:79], v3, s[36:39], s50 offen sc1
    s_branch L_rownc_36
L_rown_35:
    ds_read_b128 v[76:79], v7
L_rownc_36:
    s_cmp_eq_u32 s13, 4
    s_cbranch_scc1 L_rown_37
    s_mov_b32 s50, 4096
    buffer_load_dwordx4 v[80:83], v3, s[36:39], s50 offen sc1
    s_branch L_rownc_38
L_rown_37:
    ds_read_b128 v[80:83], v7
L_rownc_38:
    s_cmp_eq_u32 s13, 5
    s_cbranch_scc1 L_rown_39
    s_mov_b32 s50, 5120
    buffer_load_dwordx4 v[84:87], v3, s[36:39], s50 offen sc1
    s_branch L_rownc_40
L_rown_39:
    ds_read_b128 v[84:87], v7
L_rownc_40:
    s_cmp_eq_u32 s13, 6
    s_cbranch_scc1 L_rown_41
    s_mov_b32 s50, 6144
    buffer_load_dwordx4 v[88:91], v3, s[36:39], s50 offen sc1
    s_branch L_rownc_42
L_rown_41:
    ds_read_b128 v[88:91], v7
L_rownc_42:
    s_cmp_eq_u32 s13, 7
    s_cbranch_scc1 L_rown_43
    s_mov_b32 s50, 7168
    buffer_load_dwordx4 v[92:95], v3, s[36:39], s50 offen sc1
    s_branch L_rownc_44
L_rown_43:
    ds_read_b128 v[92:95], v7
L_rownc_44:
    buffer_load_dword v18, v6, s[36:39], 0 offen sc1
    buffer_load_dword v19, v6, s[36:39], 0 offen offset:256 sc1
    s_waitcnt lgkmcnt(0)
    s_waitcnt vmcnt(8)
    v_alignbit_b32 v109, v65, v65, 25
    v_alignbit_b32 v110, v66, v66, 19
    v_add3_u32 v100, v64, v109, v110
    v_alignbit_b32 v109, v67, v67, 9
    v_add_u32 v100, v100, v109
    v_mul_lo_u32 v100, v100, v108
    v_lshrrev_b32 v109, 16, v100
    v_xor_b32 v100, v100, v109
    v_lshlrev_b32 v8, 16, v64
    v_and_b32 v9, 0xffff0000, v64
    v_lshlrev_b32 v10, 16, v65
    v_and_b32 v11, 0xffff0000, v65
    v_lshlrev_b32 v12, 16, v66
    v_and_b32 v13, 0xffff0000, v66
    v_lshlrev_b32 v14, 16, v67
    v_and_b32 v15, 0xffff0000, v67
    s_waitcnt vmcnt(7)
    v_alignbit_b32 v109, v69, v69, 25
    v_alignbit_b32 v110, v70, v70, 19
    v_add3_u32 v101, v68, v109, v110
    v_alignbit_b32 v109, v71, v71, 9
    v_add_u32 v101, v101, v109
    v_mul_lo_u32 v101, v101, v108
    v_lshrrev_b32 v109, 16, v101
    v_xor_b32 v101, v101, v109
    v_lshlrev_b32 v16, 16, v68
    v_and_b32 v17, 0xffff0000, v68
    v_add_f32 v8, v8, v16
    v_add_f32 v9, v9, v17
    v_lshlrev_b32 v16, 16, v69
    v_and_b32 v17, 0xffff0000, v69
    v_add_f32 v10, v10, v16
    v_add_f32 v11, v11, v17
    v_lshlrev_b32 v16, 16, v70
    v_and_b32 v17, 0xffff0000, v70
    v_add_f32 v12, v12, v16
    v_add_f32 v13, v13, v17
    v_lshlrev_b32 v16, 16, v71
    v_and_b32 v17, 0xffff0000, v71
    v_add_f32 v14, v14, v16
    v_add_f32 v15, v15, v17
    s_waitcnt vmcnt(6)
    v_alignbit_b32 v109, v73, v73, 25
    v_alignbit_b32 v110, v74, v74, 19
    v_add3_u32 v102, v72, v109, v110
    v_alignbit_b32 v109, v75, v75, 9
    v_add_u32 v102, v102, v109
    v_mul_lo_u32 v102, v102, v108
    v_lshrrev_b32 v109, 16, v102
    v_xor_b32 v102, v102, v109
    v_lshlrev_b32 v16, 16, v72
    v_and_b32 v17, 0xffff0000, v72
    v_add_f32 v8, v8, v16
    v_add_f32 v9, v9, v17
    v_lshlrev_b32 v16, 16, v73
    v_and_b32 v17, 0xffff0000, v73
    v_add_f32 v10, v10, v16
    v_add_f32 v11, v11, v17
    v_lshlrev_b32 v16, 16, v74
    v_and_b32 v17, 0xffff0000, v74
    v_add_f32 v12, v12, v16
    v_add_f32 v13, v13, v17
    v_lshlrev_b32 v16, 16, v75
    v_and_b32 v17, 0xffff0000, v75
    v_add_f32 v14, v14, v16
    v_add_f32 v15, v15, v17
    s_waitcnt vmcnt(5)
    v_alignbit_b32 v109, v77, v77, 25
    v_alignbit_b32 v110, v78, v78, 19
    v_add3_u32 v103, v76, v109, v110
    v_alignbit_b32 v109, v79, v79, 9
    v_add_u32 v103, v103, v109
    v_mul_lo_u32 v103, v103, v108
    v_lshrrev_b32 v109, 16, v103
    v_xor_b32 v103, v103, v109
    v_lshlrev_b32 v16, 16, v76
    v_and_b32 v17, 0xffff0000, v76
    v_add_f32 v8, v8, v16
    v_add_f32 v9, v9, v17
    v_lshlrev_b32 v16, 16, v77
    v_and_b32 v17, 0xffff0000, v77
    v_add_f32 v10, v10, v16
    v_add_f32 v11, v11, v17
    v_lshlrev_b32 v16, 16, v78
    v_and_b32 v17, 0xffff0000, v78
    v_add_f32 v12, v12, v16
    v_add_f32 v13, v13, v17
    v_lshlrev_b32 v16, 16, v79
    v_and_b32 v17, 0xffff0000, v79
    v_add_f32 v14, v14, v16
    v_add_f32 v15, v15, v17
    s_waitcnt vmcnt(4)
    v_alignbit_b32 v109, v81, v81, 25
    v_alignbit_b32 v110, v82, v82, 19
    v_add3_u32 v104, v80, v109, v110
    v_alignbit_b32 v109, v83, v83, 9
    v_add_u32 v104, v104, v109
    v_mul_lo_u32 v104, v104, v108
    v_lshrrev_b32 v109, 16, v104
    v_xor_b32 v104, v104, v109
    v_lshlrev_b32 v16, 16, v80
    v_and_b32 v17, 0xffff0000, v80
    v_add_f32 v8, v8, v16
    v_add_f32 v9, v9, v17
    v_lshlrev_b32 v16, 16, v81
    v_and_b32 v17, 0xffff0000, v81
    v_add_f32 v10, v10, v16
    v_add_f32 v11, v11, v17
    v_lshlrev_b32 v16, 16, v82
    v_and_b32 v17, 0xffff0000, v82
    v_add_f32 v12, v12, v16
    v_add_f32 v13, v13, v17
    v_lshlrev_b32 v16, 16, v83
    v_and_b32 v17, 0xffff0000, v83
    v_add_f32 v14, v14, v16
    v_add_f32 v15, v15, v17
    s_waitcnt vmcnt(3)
    v_alignbit_b32 v109, v85, v85, 25
    v_alignbit_b32 v110, v86, v86, 19
    v_add3_u32 v105, v84, v109, v110
    v_alignbit_b32 v109, v87, v87, 9
    v_add_u32 v105, v105, v109
    v_mul_lo_u32 v105, v105, v108
    v_lshrrev_b32 v109, 16, v105
    v_xor_b32 v105, v105, v109
    v_lshlrev_b32 v16, 16, v84
    v_and_b32 v17, 0xffff0000, v84
    v_add_f32 v8, v8, v16
    v_add_f32 v9, v9, v17
    v_lshlrev_b32 v16, 16, v85
    v_and_b32 v17, 0xffff0000, v85
    v_add_f32 v10, v10, v16
    v_add_f32 v11, v11, v17
    v_lshlrev_b32 v16, 16, v86
    v_and_b32 v17, 0xffff0000, v86
    v_add_f32 v12, v12, v16
    v_add_f32 v13, v13, v17
    v_lshlrev_b32 v16, 16, v87
    v_and_b32 v17, 0xffff0000, v87
    v_add_f32 v14, v14, v16
    v_add_f32 v15, v15, v17
    s_waitcnt vmcnt(2)
    v_alignbit_b32 v109, v89, v89, 25
    v_alignbit_b32 v110, v90, v90, 19
    v_add3_u32 v106, v88, v109, v110
    v_alignbit_b32 v109, v91, v91, 9
    v_add_u32 v106, v106, v109
    v_mul_lo_u32 v106, v106, v108
    v_lshrrev_b32 v109, 16, v106
    v_xor_b32 v106, v106, v109
    v_lshlrev_b32 v16, 16, v88
    v_and_b32 v17, 0xffff0000, v88
    v_add_f32 v8, v8, v16
    v_add_f32 v9, v9, v17
    v_lshlrev_b32 v16, 16, v89
    v_and_b32 v17, 0xffff0000, v89
    v_add_f32 v10, v10, v16
    v_add_f32 v11, v11, v17
    v_lshlrev_b32 v16, 16, v90
    v_and_b32 v17, 0xffff0000, v90
    v_add_f32 v12, v12, v16
    v_add_f32 v13, v13, v17
    v_lshlrev_b32 v16, 16, v91
    v_and_b32 v17, 0xffff0000, v91
    v_add_f32 v14, v14, v16
    v_add_f32 v15, v15, v17
    s_waitcnt vmcnt(2)
    v_alignbit_b32 v109, v93, v93, 25
    v_alignbit_b32 v110, v94, v94, 19
    v_add3_u32 v107, v92, v109, v110
    v_alignbit_b32 v109, v95, v95, 9
    v_add_u32 v107, v107, v109
    v_mul_lo_u32 v107, v107, v108
    v_lshrrev_b32 v109, 16, v107
    v_xor_b32 v107, v107, v109
    v_lshlrev_b32 v16, 16, v92
    v_and_b32 v17, 0xffff0000, v92
    v_add_f32 v8, v8, v16
    v_add_f32 v9, v9, v17
    v_lshlrev_b32 v16, 16, v93
    v_and_b32 v17, 0xffff0000, v93
    v_add_f32 v10, v10, v16
    v_add_f32 v11, v11, v17
    v_lshlrev_b32 v16, 16, v94
    v_and_b32 v17, 0xffff0000, v94
    v_add_f32 v12, v12, v16
    v_add_f32 v13, v13, v17
    v_lshlrev_b32 v16, 16, v95
    v_and_b32 v17, 0xffff0000, v95
    v_add_f32 v14, v14, v16
    v_add_f32 v15, v15, v17
    s_nop 1
    v_permlane32_swap_b32 v100, v101
    v_permlane32_swap_b32 v102, v103
    v_permlane32_swap_b32 v104, v105
    v_permlane32_swap_b32 v106, v107
    s_nop 1
    v_xor_b32 v100, v100, v101
    v_xor_b32 v102, v102, v103
    v_xor_b32 v104, v104, v105
    v_xor_b32 v106, v106, v107
    s_nop 1
    v_permlane16_swap_b32 v100, v102
    v_permlane16_swap_b32 v104, v106
    s_nop 1
    v_xor_b32 v100, v100, v102
    v_xor_b32 v104, v104, v106
    s_nop 1
    v_xor_b32_dpp v100, v100, v100 row_ror:8 row_mask:0xf bank_mask:0xf
    v_xor_b32_dpp v104, v104, v104 row_ror:8 row_mask:0xf bank_mask:0xf
    s_nop 1
    v_xor_b32_dpp v100, v100, v100 row_ror:4 row_mask:0xf bank_mask:0xf
    v_xor_b32_dpp v104, v104, v104 row_ror:4 row_mask:0xf bank_mask:0xf
    s_nop 1
    v_xor_b32_dpp v100, v100, v100 row_ror:2 row_mask:0xf bank_mask:0xf
    v_xor_b32_dpp v104, v104, v104 row_ror:2 row_mask:0xf bank_mask:0xf
    s_nop 1
    v_xor_b32_dpp v100, v100, v100 row_ror:1 row_mask:0xf bank_mask:0xf
    v_xor_b32_dpp v104, v104, v104 row_ror:1 row_mask:0xf bank_mask:0xf
    s_waitcnt vmcnt(0) lgkmcnt(0)
    v_xor_b32 v100, s74, v100
    v_xor_b32 v104, s74, v104
    v_xor_b32 v100, v100, v18
    v_xor_b32 v104, v104, v19
    v_or_b32 v100, v100, v104
    v_cmp_ne_u32 vcc, 0, v100
    s_cbranch_vccnz L_retry_27
    s_mov_b32 s24, s6
    s_and_b32 s25, s7, 0xffff
    s_mov_b32 s26, 0x120000
    s_mov_b32 s27, 0x00020000
    v_cvt_pk_bf16_f32 v20, v8, v9
    v_cvt_pk_bf16_f32 v21, v10, v11
    v_cvt_pk_bf16_f32 v22, v12, v13
    v_cvt_pk_bf16_f32 v23, v14, v15
    s_mov_b32 s50, 18432
    buffer_store_dwordx2 v[20:21], v4, s[24:27], 0 offen
    buffer_store_dwordx2 v[22:23], v4, s[24:27], s50 offen
L_notask_25:
    s_branch L_fin_3
.p2align 6
L_loader_2:
    s_load_dwordx2 s[72:73], s[0:1], 48
    v_lshrrev_b32 v11, 4, v2
    v_and_b32 v12, 15, v2
    v_lshlrev_b32 v13, 2, v11
    v_xor_b32 v12, v12, v13
    v_lshlrev_b32 v12, 4, v12
    v_lshlrev_b32 v3, 13, v11
    v_add_u32 v3, v3, v12
    s_lshl_b32 s44, s12, 17
    s_lshl_b32 s45, s17, 8
    s_add_u32 s44, s44, s45
    v_add_u32 v3, s44, v3
    v_lshrrev_b32 v11, 3, v2
    v_lshrrev_b32 v13, 1, v11
    v_and_b32 v12, 7, v2
    v_xor_b32 v12, v12, v13
    v_lshlrev_b32 v12, 4, v12
    s_movk_i32 s45, 1152
    v_mul_lo_u32 v11, v11, s45
    s_lshl_b32 s44, s46, 5
    s_mul_i32 s44, s44, 1152
    v_add_u32 v11, s44, v11
    v_add_u32 v4, v11, v12
    v_xor_b32 v12, 64, v12
    v_add_u32 v5, v11, v12
    s_lshl_b32 s55, s19, 1
    s_add_u32 s55, s55, s18
    s_and_b32 s55, s55, 7
    s_mov_b32 s54, 0
    s_waitcnt lgkmcnt(0)
    s_mov_b32 s20, s4
    s_and_b32 s21, s5, 0xffff
    s_mov_b32 s22, 0x120000
    s_mov_b32 s23, 0x00020000
    s_mov_b32 s32, s10
    s_and_b32 s33, s11, 0xffff
    s_mov_b32 s34, 0x480000
    s_mov_b32 s35, 0x00020000
    s_lshl_b32 s56, s54, 19
    s_lshl_b32 s57, s54, 7
    s_add_u32 s50, s56, 0
    s_add_u32 m0, s48, 0
    s_nop 0
    buffer_load_dwordx4 v3, s[32:35], s50 offen  lds
    s_add_u32 s50, s56, 32768
    s_add_u32 m0, s48, 1024
    s_nop 0
    buffer_load_dwordx4 v3, s[32:35], s50 offen  lds
    s_add_u32 s50, s56, 65536
    s_add_u32 m0, s48, 2048
    s_nop 0
    buffer_load_dwordx4 v3, s[32:35], s50 offen  lds
    s_add_u32 s50, s56, 98304
    s_add_u32 m0, s48, 3072
    s_nop 0
    buffer_load_dwordx4 v3, s[32:35], s50 offen  lds
    s_add_u32 s50, s57, 0
    s_add_u32 m0, s48, 16384
    s_nop 0
    buffer_load_dwordx4 v4, s[20:23], s50 offen  lds
    s_add_u32 s50, s57, 9216
    s_add_u32 m0, s48, 17408
    s_nop 0
    buffer_load_dwordx4 v5, s[20:23], s50 offen  lds
    s_add_u32 s50, s57, 18432
    s_add_u32 m0, s48, 18432
    s_nop 0
    buffer_load_dwordx4 v4, s[20:23], s50 offen  lds
    s_add_u32 s50, s57, 27648
    s_add_u32 m0, s48, 19456
    s_nop 0
    buffer_load_dwordx4 v5, s[20:23], s50 offen  lds
    s_add_u32 s54, s55, 0
    s_and_b32 s54, s54, 7
    s_add_u32 s54, s54, 1
    s_getpc_b64 s[58:59]
L_pc_45:
    s_sub_u32 s58, s58, L_pc_45 - standalone__mha_block_cached__near_ridge_kernel
    s_subb_u32 s59, s59, 0
    s_lshl_b32 s60, s12, 13
    v_lshlrev_b32 v56, 7, v2
    v_add_u32 v56, s60, v56
    v_min_u32 v56, L_code_end - standalone__mha_block_cached__near_ridge_kernel - 4, v56
    global_load_dword v43, v56, s[58:59]
    s_lshl_b32 s56, s54, 19
    s_lshl_b32 s57, s54, 7
    s_add_u32 s50, s56, 0
    s_add_u32 m0, s48, 32768
    s_nop 0
    buffer_load_dwordx4 v3, s[32:35], s50 offen  lds
    s_add_u32 s50, s56, 32768
    s_add_u32 m0, s48, 33792
    s_nop 0
    buffer_load_dwordx4 v3, s[32:35], s50 offen  lds
    s_add_u32 s50, s56, 65536
    s_add_u32 m0, s48, 34816
    s_nop 0
    buffer_load_dwordx4 v3, s[32:35], s50 offen  lds
    s_add_u32 s50, s56, 98304
    s_add_u32 m0, s48, 35840
    s_nop 0
    buffer_load_dwordx4 v3, s[32:35], s50 offen  lds
    s_add_u32 s50, s57, 0
    s_add_u32 m0, s48, 49152
    s_nop 0
    buffer_load_dwordx4 v4, s[20:23], s50 offen  lds
    s_add_u32 s50, s57, 9216
    s_add_u32 m0, s48, 50176
    s_nop 0
    buffer_load_dwordx4 v5, s[20:23], s50 offen  lds
    s_add_u32 s50, s57, 18432
    s_add_u32 m0, s48, 51200
    s_nop 0
    buffer_load_dwordx4 v4, s[20:23], s50 offen  lds
    s_add_u32 s50, s57, 27648
    s_add_u32 m0, s48, 52224
    s_nop 0
    buffer_load_dwordx4 v5, s[20:23], s50 offen  lds
    s_add_u32 s54, s55, 1
    s_and_b32 s54, s54, 7
    s_add_u32 s54, s54, 1
    s_mov_b32 s24, s6
    s_and_b32 s25, s7, 0xffff
    s_mov_b32 s26, 0x800000
    s_mov_b32 s27, 0x00020000
    s_mov_b32 s28, s8
    s_and_b32 s29, s9, 0xffff
    s_mov_b32 s30, 0x800000
    s_mov_b32 s31, 0x00020000
    s_mov_b32 s40, s96
    s_and_b32 s41, s97, 0xffff
    s_mov_b32 s42, 0x480000
    s_mov_b32 s43, 0x00020000
    s_mov_b32 s36, s14
    s_and_b32 s37, s15, 0xffff
    s_mov_b32 s38, 0x10000000
    s_mov_b32 s39, 0x00020000
    s_mov_b32 s68, s72
    s_and_b32 s69, s73, 0xffff
    s_mov_b32 s70, 0x100
    s_mov_b32 s71, 0x00020000
    v_lshrrev_b32 v11, 4, v2
    v_and_b32 v12, 15, v2
    v_xor_b32 v12, v12, v11
    v_lshlrev_b32 v12, 4, v12
    v_xor_b32 v13, 0, v12
    v_lshlrev_b32 v6, 8, v11
    v_add_u32 v6, v6, v13
    v_add_u32 v6, s47, v6
    v_xor_b32 v13, 64, v12
    v_lshlrev_b32 v7, 8, v11
    v_add_u32 v7, v7, v13
    v_add_u32 v7, s47, v7
    v_xor_b32 v13, 128, v12
    v_lshlrev_b32 v8, 8, v11
    v_add_u32 v8, v8, v13
    v_add_u32 v8, s47, v8
    v_xor_b32 v13, 192, v12
    v_lshlrev_b32 v9, 8, v11
    v_add_u32 v9, v9, v13
    v_add_u32 v9, s47, v9
    v_lshrrev_b32 v11, 3, v2
    v_lshrrev_b32 v13, 1, v11
    v_and_b32 v12, 7, v2
    v_xor_b32 v12, v12, v13
    v_lshlrev_b32 v12, 4, v12
    v_lshlrev_b32 v11, 8, v11
    s_lshl_b32 s58, s46, 5
    s_lshl_b32 s59, s13, 2
    s_add_u32 s58, s58, s59
    s_lshl_b32 s59, s58, 13
    v_add_u32 v11, s59, v11
    v_add_u32 v14, v11, v12
    v_xor_b32 v12, 64, v12
    v_add_u32 v15, v11, v12
    s_lshl_b32 s58, s58, 11
    s_add_u32 s58, s58, 251658240
    v_lshlrev_b32 v21, 4, v2
    v_add_u32 v21, s58, v21
    s_mov_b32 s60, 0x0CCCCCCD
    s_mul_i32 s58, s19, 288
    s_and_b32 s59, s19, 1
    s_lshl_b32 s59, s59, 5
    s_sub_u32 s58, s58, s59
    s_mov_b32 s75, s58
    s_lshl_b32 s59, s13, 9
    s_lshl_b32 s61, s12, 4
    s_add_u32 s59, s59, s61
    s_mul_i32 s59, s59, 1152
    s_add_u32 s58, s58, s59
    s_movk_i32 s45, 1152
    v_add_u32 v11, 0, v2
    v_mul_hi_u32 v12, v11, s60
    v_mul_u32_u24 v13, 20, v12
    v_sub_u32 v11, v11, v13
    v_bfe_u32 v13, v12, 3, 1
    v_lshlrev_b32 v13, 1, v13
    v_xor_b32 v11, v11, v13
    v_lshlrev_b32 v11, 4, v11
    v_mul_lo_u32 v12, v12, s45
    v_add_u32 v11, v11, v12
    v_add_u32 v16, s58, v11
    v_add_u32 v11, 64, v2
    v_mul_hi_u32 v12, v11, s60
    v_mul_u32_u24 v13, 20, v12
    v_sub_u32 v11, v11, v13
    v_bfe_u32 v13, v12, 3, 1
    v_lshlrev_b32 v13, 1, v13
    v_xor_b32 v11, v11, v13
    v_lshlrev_b32 v11, 4, v11
    v_mul_lo_u32 v12, v12, s45
    v_add_u32 v11, v11, v12
    v_add_u32 v17, s58, v11
    v_add_u32 v11, 128, v2
    v_mul_hi_u32 v12, v11, s60
    v_mul_u32_u24 v13, 20, v12
    v_sub_u32 v11, v11, v13
    v_bfe_u32 v13, v12, 3, 1
    v_lshlrev_b32 v13, 1, v13
    v_xor_b32 v11, v11, v13
    v_lshlrev_b32 v11, 4, v11
    v_mul_lo_u32 v12, v12, s45
    v_add_u32 v11, v11, v12
    v_add_u32 v18, s58, v11
    v_add_u32 v11, 192, v2
    v_mul_hi_u32 v12, v11, s60
    v_mul_u32_u24 v13, 20, v12
    v_sub_u32 v11, v11, v13
    v_bfe_u32 v13, v12, 3, 1
    v_lshlrev_b32 v13, 1, v13
    v_xor_b32 v11, v11, v13
    v_lshlrev_b32 v11, 4, v11
    v_mul_lo_u32 v12, v12, s45
    v_add_u32 v11, v11, v12
    v_add_u32 v19, s58, v11
    v_add_u32 v11, 256, v2
    v_mul_hi_u32 v12, v11, s60
    v_mul_u32_u24 v13, 20, v12
    v_sub_u32 v11, v11, v13
    v_bfe_u32 v13, v12, 3, 1
    v_lshlrev_b32 v13, 1, v13
    v_xor_b32 v11, v11, v13
    v_lshlrev_b32 v11, 4, v11
    v_mul_lo_u32 v12, v12, s45
    v_add_u32 v11, v11, v12
    v_add_u32 v20, s58, v11
    s_add_u32 s62, s19, s18
    s_and_b32 s62, s62, 3
    s_lshl_b32 s67, s12, 12
    s_add_u32 s67, s67, 81920
    s_mul_i32 s63, s12, 5120
    v_lshlrev_b32 v22, 7, v2
    v_add_u32 v22, s47, v22
    v_lshrrev_b32 v11, 2, v2
    s_lshl_b32 s59, s13, 9
    s_lshl_b32 s61, s18, 6
    s_add_u32 s59, s59, s61
    s_lshl_b32 s61, s12, 4
    s_add_u32 s59, s59, s61
    v_add_u32 v11, s59, v11
    v_mul_lo_u32 v11, v11, s45
    v_and_b32 v12, 3, v2
    v_lshlrev_b32 v12, 7, v12
    v_add_u32 v11, v11, v12
    v_add_u32 v23, s75, v11
    v_and_b32 v12, 3, v2
    v_cmp_eq_u32 vcc, 3, v12
    v_subrev_u32 v12, 68, v23
    s_nop 1
    v_cndmask_b32 v23, v23, v12, vcc
    s_or_b32 s58, s2, s12
    s_cmp_lg_u32 s58, 0
    s_cbranch_scc1 L_nopub_46
    s_memrealtime s[58:59]
    s_waitcnt lgkmcnt(0)
    s_or_b32 s58, s58, 1
    v_mov_b32 v30, s58
    v_mov_b32 v31, 0
    s_mov_b64 s[76:77], exec
    s_mov_b64 exec, 1
    buffer_store_dword v30, v31, s[68:71], 0 offen sc1
    s_mov_b64 exec, s[76:77]
L_nopub_46:
    v_mov_b32 v31, 0
    s_waitcnt vmcnt(9)
    s_barrier
    s_lshl_b32 s56, s54, 19
    s_lshl_b32 s57, s54, 7
    s_add_u32 s50, s56, 0
    s_add_u32 m0, s48, 65536
    s_nop 0
    buffer_load_dwordx4 v3, s[32:35], s50 offen  lds
    s_add_u32 s50, s56, 32768
    s_add_u32 m0, s48, 66560
    s_nop 0
    buffer_load_dwordx4 v3, s[32:35], s50 offen  lds
    s_add_u32 s50, s56, 65536
    s_add_u32 m0, s48, 67584
    s_nop 0
    buffer_load_dwordx4 v3, s[32:35], s50 offen  lds
    s_add_u32 s50, s56, 98304
    s_add_u32 m0, s48, 68608
    s_nop 0
    buffer_load_dwordx4 v3, s[32:35], s50 offen  lds
    s_add_u32 s50, s57, 0
    s_add_u32 m0, s48, 81920
    s_nop 0
    buffer_load_dwordx4 v4, s[20:23], s50 offen  lds
    s_add_u32 s50, s57, 9216
    s_add_u32 m0, s48, 82944
    s_nop 0
    buffer_load_dwordx4 v5, s[20:23], s50 offen  lds
    s_add_u32 s50, s57, 18432
    s_add_u32 m0, s48, 83968
    s_nop 0
    buffer_load_dwordx4 v4, s[20:23], s50 offen  lds
    s_add_u32 s50, s57, 27648
    s_add_u32 m0, s48, 84992
    s_nop 0
    buffer_load_dwordx4 v5, s[20:23], s50 offen  lds
    s_add_u32 s54, s55, 2
    s_and_b32 s54, s54, 7
    s_add_u32 s54, s54, 1
    s_waitcnt vmcnt(8)
    s_barrier
    s_lshl_b32 s56, s54, 19
    s_lshl_b32 s57, s54, 7
    s_add_u32 s50, s56, 0
    s_add_u32 m0, s48, 98304
    s_nop 0
    buffer_load_dwordx4 v3, s[32:35], s50 offen  lds
    s_add_u32 s50, s56, 32768
    s_add_u32 m0, s48, 99328
    s_nop 0
    buffer_load_dwordx4 v3, s[32:35], s50 offen  lds
    s_add_u32 s50, s56, 65536
    s_add_u32 m0, s48, 100352
    s_nop 0
    buffer_load_dwordx4 v3, s[32:35], s50 offen  lds
    s_add_u32 s50, s56, 98304
    s_add_u32 m0, s48, 101376
    s_nop 0
    buffer_load_dwordx4 v3, s[32:35], s50 offen  lds
    s_add_u32 s50, s57, 0
    s_add_u32 m0, s48, 114688
    s_nop 0
    buffer_load_dwordx4 v4, s[20:23], s50 offen  lds
    s_add_u32 s50, s57, 9216
    s_add_u32 m0, s48, 115712
    s_nop 0
    buffer_load_dwordx4 v5, s[20:23], s50 offen  lds
    s_add_u32 s50, s57, 18432
    s_add_u32 m0, s48, 116736
    s_nop 0
    buffer_load_dwordx4 v4, s[20:23], s50 offen  lds
    s_add_u32 s50, s57, 27648
    s_add_u32 m0, s48, 117760
    s_nop 0
    buffer_load_dwordx4 v5, s[20:23], s50 offen  lds
    s_add_u32 s54, s55, 3
    s_and_b32 s54, s54, 7
    s_add_u32 s54, s54, 1
    s_waitcnt vmcnt(8)
    s_barrier
    s_lshl_b32 s56, s54, 19
    s_lshl_b32 s57, s54, 7
    s_add_u32 s50, s56, 0
    s_add_u32 m0, s48, 0
    s_nop 0
    buffer_load_dwordx4 v3, s[32:35], s50 offen  lds
    s_add_u32 s50, s56, 32768
    s_add_u32 m0, s48, 1024
    s_nop 0
    buffer_load_dwordx4 v3, s[32:35], s50 offen  lds
    s_add_u32 s50, s56, 65536
    s_add_u32 m0, s48, 2048
    s_nop 0
    buffer_load_dwordx4 v3, s[32:35], s50 offen  lds
    s_add_u32 s50, s56, 98304
    s_add_u32 m0, s48, 3072
    s_nop 0
    buffer_load_dwordx4 v3, s[32:35], s50 offen  lds
    s_add_u32 s50, s57, 0
    s_add_u32 m0, s48, 16384
    s_nop 0
    buffer_load_dwordx4 v4, s[20:23], s50 offen  lds
    s_add_u32 s50, s57, 9216
    s_add_u32 m0, s48, 17408
    s_nop 0
    buffer_load_dwordx4 v5, s[20:23], s50 offen  lds
    s_add_u32 s50, s57, 18432
    s_add_u32 m0, s48, 18432
    s_nop 0
    buffer_load_dwordx4 v4, s[20:23], s50 offen  lds
    s_add_u32 s50, s57, 27648
    s_add_u32 m0, s48, 19456
    s_nop 0
    buffer_load_dwordx4 v5, s[20:23], s50 offen  lds
    s_add_u32 s54, s55, 4
    s_and_b32 s54, s54, 7
    s_add_u32 s54, s54, 1
    s_waitcnt vmcnt(8)
    s_barrier
    s_lshl_b32 s56, s54, 19
    s_lshl_b32 s57, s54, 7
    s_add_u32 s50, s56, 0
    s_add_u32 m0, s48, 32768
    s_nop 0
    buffer_load_dwordx4 v3, s[32:35], s50 offen  lds
    s_add_u32 s50, s56, 32768
    s_add_u32 m0, s48, 33792
    s_nop 0
    buffer_load_dwordx4 v3, s[32:35], s50 offen  lds
    s_add_u32 s50, s56, 65536
    s_add_u32 m0, s48, 34816
    s_nop 0
    buffer_load_dwordx4 v3, s[32:35], s50 offen  lds
    s_add_u32 s50, s56, 98304
    s_add_u32 m0, s48, 35840
    s_nop 0
    buffer_load_dwordx4 v3, s[32:35], s50 offen  lds
    s_add_u32 s50, s57, 0
    s_add_u32 m0, s48, 49152
    s_nop 0
    buffer_load_dwordx4 v4, s[20:23], s50 offen  lds
    s_add_u32 s50, s57, 9216
    s_add_u32 m0, s48, 50176
    s_nop 0
    buffer_load_dwordx4 v5, s[20:23], s50 offen  lds
    s_add_u32 s50, s57, 18432
    s_add_u32 m0, s48, 51200
    s_nop 0
    buffer_load_dwordx4 v4, s[20:23], s50 offen  lds
    s_add_u32 s50, s57, 27648
    s_add_u32 m0, s48, 52224
    s_nop 0
    buffer_load_dwordx4 v5, s[20:23], s50 offen  lds
    s_add_u32 s54, s55, 5
    s_and_b32 s54, s54, 7
    s_add_u32 s54, s54, 1
    s_waitcnt vmcnt(8)
    s_barrier
    s_lshl_b32 s56, s54, 19
    s_lshl_b32 s57, s54, 7
    s_add_u32 s50, s56, 0
    s_add_u32 m0, s48, 65536
    s_nop 0
    buffer_load_dwordx4 v3, s[32:35], s50 offen  lds
    s_add_u32 s50, s56, 32768
    s_add_u32 m0, s48, 66560
    s_nop 0
    buffer_load_dwordx4 v3, s[32:35], s50 offen  lds
    s_add_u32 s50, s56, 65536
    s_add_u32 m0, s48, 67584
    s_nop 0
    buffer_load_dwordx4 v3, s[32:35], s50 offen  lds
    s_add_u32 s50, s56, 98304
    s_add_u32 m0, s48, 68608
    s_nop 0
    buffer_load_dwordx4 v3, s[32:35], s50 offen  lds
    s_add_u32 s50, s57, 0
    s_add_u32 m0, s48, 81920
    s_nop 0
    buffer_load_dwordx4 v4, s[20:23], s50 offen  lds
    s_add_u32 s50, s57, 9216
    s_add_u32 m0, s48, 82944
    s_nop 0
    buffer_load_dwordx4 v5, s[20:23], s50 offen  lds
    s_add_u32 s50, s57, 18432
    s_add_u32 m0, s48, 83968
    s_nop 0
    buffer_load_dwordx4 v4, s[20:23], s50 offen  lds
    s_add_u32 s50, s57, 27648
    s_add_u32 m0, s48, 84992
    s_nop 0
    buffer_load_dwordx4 v5, s[20:23], s50 offen  lds
    s_add_u32 s54, s55, 6
    s_and_b32 s54, s54, 7
    s_add_u32 s54, s54, 1
    s_mov_b32 s50, 0
    s_add_u32 m0, s49, 131072
    s_nop 0
    buffer_load_dwordx4 v6, s[24:27], s50 offen  lds
    s_mov_b32 s50, 1024
    s_add_u32 m0, s49, 132096
    s_nop 0
    buffer_load_dwordx4 v7, s[24:27], s50 offen  lds
    s_mov_b32 s50, 2048
    s_add_u32 m0, s49, 133120
    s_nop 0
    buffer_load_dwordx4 v8, s[24:27], s50 offen  lds
    s_mov_b32 s50, 3072
    s_add_u32 m0, s49, 134144
    s_nop 0
    buffer_load_dwordx4 v9, s[24:27], s50 offen  lds
    s_mov_b32 s50, 4096
    s_add_u32 m0, s49, 135168
    s_nop 0
    buffer_load_dwordx4 v6, s[24:27], s50 offen  lds
    s_mov_b32 s50, 5120
    s_add_u32 m0, s49, 136192
    s_nop 0
    buffer_load_dwordx4 v7, s[24:27], s50 offen  lds
    s_mov_b32 s50, 6144
    s_add_u32 m0, s49, 137216
    s_nop 0
    buffer_load_dwordx4 v8, s[24:27], s50 offen  lds
    s_mov_b32 s50, 7168
    s_add_u32 m0, s49, 138240
    s_nop 0
    buffer_load_dwordx4 v9, s[24:27], s50 offen  lds
    buffer_load_dword v32, v31, s[68:71], 0 offen sc1
    s_waitcnt vmcnt(17)
    s_barrier
    s_lshl_b32 s56, s54, 19
    s_lshl_b32 s57, s54, 7
    s_add_u32 s50, s56, 0
    s_add_u32 m0, s48, 98304
    s_nop 0
    buffer_load_dwordx4 v3, s[32:35], s50 offen  lds
    s_add_u32 s50, s56, 32768
    s_add_u32 m0, s48, 99328
    s_nop 0
    buffer_load_dwordx4 v3, s[32:35], s50 offen  lds
    s_add_u32 s50, s56, 65536
    s_add_u32 m0, s48, 100352
    s_nop 0
    buffer_load_dwordx4 v3, s[32:35], s50 offen  lds
    s_add_u32 s50, s56, 98304
    s_add_u32 m0, s48, 101376
    s_nop 0
    buffer_load_dwordx4 v3, s[32:35], s50 offen  lds
    s_add_u32 s50, s57, 0
    s_add_u32 m0, s48, 114688
    s_nop 0
    buffer_load_dwordx4 v4, s[20:23], s50 offen  lds
    s_add_u32 s50, s57, 9216
    s_add_u32 m0, s48, 115712
    s_nop 0
    buffer_load_dwordx4 v5, s[20:23], s50 offen  lds
    s_add_u32 s50, s57, 18432
    s_add_u32 m0, s48, 116736
    s_nop 0
    buffer_load_dwordx4 v4, s[20:23], s50 offen  lds
    s_add_u32 s50, s57, 27648
    s_add_u32 m0, s48, 117760
    s_nop 0
    buffer_load_dwordx4 v5, s[20:23], s50 offen  lds
    s_add_u32 s54, s55, 7
    s_and_b32 s54, s54, 7
    s_add_u32 s54, s54, 1
    s_waitcnt vmcnt(17)
    s_barrier
    s_lshl_b32 s56, s54, 19
    s_lshl_b32 s57, s54, 7
    s_add_u32 s50, s56, 0
    s_add_u32 m0, s48, 0
    s_nop 0
    buffer_load_dwordx4 v3, s[32:35], s50 offen  lds
    s_add_u32 s50, s56, 32768
    s_add_u32 m0, s48, 1024
    s_nop 0
    buffer_load_dwordx4 v3, s[32:35], s50 offen  lds
    s_add_u32 s50, s56, 65536
    s_add_u32 m0, s48, 2048
    s_nop 0
    buffer_load_dwordx4 v3, s[32:35], s50 offen  lds
    s_add_u32 s50, s56, 98304
    s_add_u32 m0, s48, 3072
    s_nop 0
    buffer_load_dwordx4 v3, s[32:35], s50 offen  lds
    s_add_u32 s50, s57, 0
    s_add_u32 m0, s48, 16384
    s_nop 0
    buffer_load_dwordx4 v4, s[20:23], s50 offen  lds
    s_add_u32 s50, s57, 9216
    s_add_u32 m0, s48, 17408
    s_nop 0
    buffer_load_dwordx4 v5, s[20:23], s50 offen  lds
    s_add_u32 s50, s57, 18432
    s_add_u32 m0, s48, 18432
    s_nop 0
    buffer_load_dwordx4 v4, s[20:23], s50 offen  lds
    s_add_u32 s50, s57, 27648
    s_add_u32 m0, s48, 19456
    s_nop 0
    buffer_load_dwordx4 v5, s[20:23], s50 offen  lds
    s_add_u32 s54, s55, 8
    s_and_b32 s54, s54, 7
    s_add_u32 s54, s54, 1
    s_waitcnt vmcnt(8)
    s_barrier
    s_add_u32 s64, s62, 0
    s_and_b32 s64, s64, 3
    s_mul_i32 s66, s64, 147456
    s_add_u32 s50, s66, 0
    s_add_u32 m0, s63, 40960
    s_nop 0
    buffer_load_dwordx4 v16, s[40:43], s50 offen  lds
    s_add_u32 m0, s63, 41984
    s_nop 0
    buffer_load_dwordx4 v17, s[40:43], s50 offen  lds
    s_add_u32 m0, s63, 43008
    s_nop 0
    buffer_load_dwordx4 v18, s[40:43], s50 offen  lds
    s_add_u32 m0, s63, 44032
    s_nop 0
    buffer_load_dwordx4 v19, s[40:43], s50 offen  lds
    s_add_u32 m0, s63, 45056
    s_nop 0
    buffer_load_dwordx4 v20, s[40:43], s50 offen  lds
    s_waitcnt vmcnt(5)
    s_barrier
    s_add_u32 s64, s62, 0
    s_and_b32 s64, s64, 3
    s_lshl_b32 s65, s64, 13
    s_add_u32 s50, s65, 0
    s_add_u32 m0, s67, 0
    s_nop 0
    buffer_load_dwordx4 v14, s[28:31], s50 offen  lds
    s_add_u32 s50, s65, 2048
    s_add_u32 m0, s67, 1024
    s_nop 0
    buffer_load_dwordx4 v15, s[28:31], s50 offen  lds
    s_add_u32 s50, s65, 4096
    s_add_u32 m0, s67, 2048
    s_nop 0
    buffer_load_dwordx4 v14, s[28:31], s50 offen  lds
    s_add_u32 s50, s65, 6144
    s_add_u32 m0, s67, 3072
    s_nop 0
    buffer_load_dwordx4 v15, s[28:31], s50 offen  lds
    s_add_u32 s64, s62, 0
    s_and_b32 s64, s64, 3
    s_mul_i32 s66, s64, 147456
    s_add_u32 s50, s66, 73728
    s_add_u32 m0, s63, 61440
    s_nop 0
    buffer_load_dwordx4 v16, s[40:43], s50 offen  lds
    s_add_u32 m0, s63, 62464
    s_nop 0
    buffer_load_dwordx4 v17, s[40:43], s50 offen  lds
    s_add_u32 m0, s63, 63488
    s_nop 0
    buffer_load_dwordx4 v18, s[40:43], s50 offen  lds
    s_add_u32 m0, s63, 64512
    s_nop 0
    buffer_load_dwordx4 v19, s[40:43], s50 offen  lds
    s_add_u32 m0, s63, 65536
    s_nop 0
    buffer_load_dwordx4 v20, s[40:43], s50 offen  lds
L_lnonce_47:
    v_readfirstlane_b32 s74, v32
    s_nop 3
    s_cmp_lg_u32 s74, 0
    s_cbranch_scc1 L_lnonce_ok_48
    buffer_load_dword v32, v31, s[68:71], 0 offen sc1
    s_waitcnt vmcnt(0)
    s_branch L_lnonce_47
L_lnonce_ok_48:
    s_lshl_b32 s58, s18, 3
    s_add_u32 s58, s58, s13
    s_lshl_b32 s58, s58, 2
    s_add_u32 s58, s58, s12
    s_lshl_b32 s58, s58, 9
    s_add_u32 s58, s58, 264241152
    v_and_b32 v33, 3, v2
    v_lshlrev_b32 v33, 7, v33
    v_add_u32 v33, s58, v33
    s_waitcnt vmcnt(5)
    s_barrier
    s_add_u32 s64, s62, 0
    s_and_b32 s64, s64, 3
    s_lshl_b32 s65, s64, 13
    s_add_u32 s50, s65, 128
    s_add_u32 m0, s67, 16384
    s_nop 0
    buffer_load_dwordx4 v14, s[28:31], s50 offen  lds
    s_add_u32 s50, s65, 2176
    s_add_u32 m0, s67, 17408
    s_nop 0
    buffer_load_dwordx4 v15, s[28:31], s50 offen  lds
    s_add_u32 s50, s65, 4224
    s_add_u32 m0, s67, 18432
    s_nop 0
    buffer_load_dwordx4 v14, s[28:31], s50 offen  lds
    s_add_u32 s50, s65, 6272
    s_add_u32 m0, s67, 19456
    s_nop 0
    buffer_load_dwordx4 v15, s[28:31], s50 offen  lds
    s_add_u32 s64, s62, 1
    s_and_b32 s64, s64, 3
    s_lshl_b32 s65, s64, 13
    s_add_u32 s50, s65, 0
    s_add_u32 m0, s67, 32768
    s_nop 0
    buffer_load_dwordx4 v14, s[28:31], s50 offen  lds
    s_add_u32 s50, s65, 2048
    s_add_u32 m0, s67, 33792
    s_nop 0
    buffer_load_dwordx4 v15, s[28:31], s50 offen  lds
    s_add_u32 s50, s65, 4096
    s_add_u32 m0, s67, 34816
    s_nop 0
    buffer_load_dwordx4 v14, s[28:31], s50 offen  lds
    s_add_u32 s50, s65, 6144
    s_add_u32 m0, s67, 35840
    s_nop 0
    buffer_load_dwordx4 v15, s[28:31], s50 offen  lds
    s_add_u32 s64, s62, 1
    s_and_b32 s64, s64, 3
    s_mul_i32 s66, s64, 147456
    s_add_u32 s50, s66, 0
    s_add_u32 m0, s63, 0
    s_nop 0
    buffer_load_dwordx4 v16, s[40:43], s50 offen  lds
    s_add_u32 m0, s63, 1024
    s_nop 0
    buffer_load_dwordx4 v17, s[40:43], s50 offen  lds
    s_add_u32 m0, s63, 2048
    s_nop 0
    buffer_load_dwordx4 v18, s[40:43], s50 offen  lds
    s_add_u32 m0, s63, 3072
    s_nop 0
    buffer_load_dwordx4 v19, s[40:43], s50 offen  lds
    s_add_u32 m0, s63, 4096
    s_nop 0
    buffer_load_dwordx4 v20, s[40:43], s50 offen  lds
    s_waitcnt vmcnt(9)
    s_barrier
    s_add_u32 s64, s62, 1
    s_and_b32 s64, s64, 3
    s_mul_i32 s66, s64, 147456
    s_add_u32 s50, s66, 73728
    s_add_u32 m0, s63, 20480
    s_nop 0
    buffer_load_dwordx4 v16, s[40:43], s50 offen  lds
    s_add_u32 m0, s63, 21504
    s_nop 0
    buffer_load_dwordx4 v17, s[40:43], s50 offen  lds
    s_add_u32 m0, s63, 22528
    s_nop 0
    buffer_load_dwordx4 v18, s[40:43], s50 offen  lds
    s_add_u32 m0, s63, 23552
    s_nop 0
    buffer_load_dwordx4 v19, s[40:43], s50 offen  lds
    s_add_u32 m0, s63, 24576
    s_nop 0
    buffer_load_dwordx4 v20, s[40:43], s50 offen  lds
    s_add_u32 s64, s62, 1
    s_and_b32 s64, s64, 3
    s_lshl_b32 s65, s64, 13
    s_add_u32 s50, s65, 128
    s_add_u32 m0, s67, 0
    s_nop 0
    buffer_load_dwordx4 v14, s[28:31], s50 offen  lds
    s_add_u32 s50, s65, 2176
    s_add_u32 m0, s67, 1024
    s_nop 0
    buffer_load_dwordx4 v15, s[28:31], s50 offen  lds
    s_add_u32 s50, s65, 4224
    s_add_u32 m0, s67, 2048
    s_nop 0
    buffer_load_dwordx4 v14, s[28:31], s50 offen  lds
    s_add_u32 s50, s65, 6272
    s_add_u32 m0, s67, 3072
    s_nop 0
    buffer_load_dwordx4 v15, s[28:31], s50 offen  lds
    s_waitcnt vmcnt(14)
    s_waitcnt vmcnt(9)
    s_barrier
    s_add_u32 s64, s62, 2
    s_and_b32 s64, s64, 3
    s_mul_i32 s66, s64, 147456
    s_add_u32 s50, s66, 0
    s_add_u32 m0, s63, 40960
    s_nop 0
    buffer_load_dwordx4 v16, s[40:43], s50 offen  lds
    s_add_u32 m0, s63, 41984
    s_nop 0
    buffer_load_dwordx4 v17, s[40:43], s50 offen  lds
    s_add_u32 m0, s63, 43008
    s_nop 0
    buffer_load_dwordx4 v18, s[40:43], s50 offen  lds
    s_add_u32 m0, s63, 44032
    s_nop 0
    buffer_load_dwordx4 v19, s[40:43], s50 offen  lds
    s_add_u32 m0, s63, 45056
    s_nop 0
    buffer_load_dwordx4 v20, s[40:43], s50 offen  lds
    s_add_u32 s64, s62, 2
    s_and_b32 s64, s64, 3
    s_lshl_b32 s65, s64, 13
    s_add_u32 s50, s65, 0
    s_add_u32 m0, s67, 16384
    s_nop 0
    buffer_load_dwordx4 v14, s[28:31], s50 offen  lds
    s_add_u32 s50, s65, 2048
    s_add_u32 m0, s67, 17408
    s_nop 0
    buffer_load_dwordx4 v15, s[28:31], s50 offen  lds
    s_add_u32 s50, s65, 4096
    s_add_u32 m0, s67, 18432
    s_nop 0
    buffer_load_dwordx4 v14, s[28:31], s50 offen  lds
    s_add_u32 s50, s65, 6144
    s_add_u32 m0, s67, 19456
    s_nop 0
    buffer_load_dwordx4 v15, s[28:31], s50 offen  lds
    s_lshl_b32 s58, s19, 11
    s_add_u32 s58, s58, s49
    s_add_u32 s58, s58, 131072
    v_lshlrev_b32 v52, 4, v2
    v_add_u32 v53, s58, v52
    ds_read_b128 v[44:47], v53
    ds_read_b128 v[48:51], v53 offset:1024
    s_lshr_b32 s58, s47, 2
    s_add_u32 s58, s58, 251658240
    v_add_u32 v52, s58, v52
    s_waitcnt lgkmcnt(0)
    buffer_store_dwordx4 v[44:47], v52, s[36:39], 0 offen sc1
    buffer_store_dwordx4 v[48:51], v52, s[36:39], 0 offen offset:1024 sc1
    v_lshlrev_b32 v71, 1, v2
    v_or_b32 v71, 1, v71
    s_mov_b32 s61, 0x9E3779B1
    v_mul_lo_u32 v71, v71, s61
    v_alignbit_b32 v74, v45, v45, 25
    v_alignbit_b32 v75, v46, v46, 19
    v_add3_u32 v72, v44, v74, v75
    v_alignbit_b32 v74, v47, v47, 9
    v_add_u32 v72, v72, v74
    v_mul_lo_u32 v72, v72, v71
    v_lshrrev_b32 v74, 16, v72
    v_xor_b32 v72, v72, v74
    v_alignbit_b32 v74, v49, v49, 25
    v_alignbit_b32 v75, v50, v50, 19
    v_add3_u32 v73, v48, v74, v75
    v_alignbit_b32 v74, v51, v51, 9
    v_add_u32 v73, v73, v74
    v_mul_lo_u32 v73, v73, v71
    v_lshrrev_b32 v74, 16, v73
    v_xor_b32 v73, v73, v74
    v_mov_b32 v74, 0
    v_mov_b32 v75, 0
    s_nop 1
    v_permlane32_swap_b32 v72, v73
    v_permlane32_swap_b32 v74, v75
    s_nop 1
    v_xor_b32 v72, v72, v73
    v_xor_b32 v74, v74, v75
    s_nop 1
    v_permlane16_swap_b32 v72, v74
    s_nop 1
    v_xor_b32 v72, v72, v74
    s_nop 1
    v_xor_b32_dpp v72, v72, v72 row_ror:8 row_mask:0xf bank_mask:0xf
    s_nop 1
    v_xor_b32_dpp v72, v72, v72 row_ror:4 row_mask:0xf bank_mask:0xf
    s_nop 1
    v_xor_b32_dpp v72, v72, v72 row_ror:2 row_mask:0xf bank_mask:0xf
    s_nop 1
    v_xor_b32_dpp v72, v72, v72 row_ror:1 row_mask:0xf bank_mask:0xf
    v_xor_b32 v72, s74, v72
    s_lshr_b32 s58, s47, 7
    s_add_u32 s58, s58, 264503296
    v_bfe_u32 v76, v2, 5, 1
    v_lshlrev_b32 v76, 2, v76
    v_add_u32 v76, s58, v76
    s_mov_b64 s[76:77], exec
    s_mov_b32 exec_lo, 1
    s_mov_b32 exec_hi, 1
    buffer_store_dword v72, v76, s[36:39], 0 offen sc1
    s_mov_b64 exec, s[76:77]
    s_waitcnt vmcnt(12)
    s_barrier
    s_add_u32 s64, s62, 2
    s_and_b32 s64, s64, 3
    s_mul_i32 s66, s64, 147456
    s_add_u32 s50, s66, 73728
    s_add_u32 m0, s63, 61440
    s_nop 0
    buffer_load_dwordx4 v16, s[40:43], s50 offen  lds
    s_add_u32 m0, s63, 62464
    s_nop 0
    buffer_load_dwordx4 v17, s[40:43], s50 offen  lds
    s_add_u32 m0, s63, 63488
    s_nop 0
    buffer_load_dwordx4 v18, s[40:43], s50 offen  lds
    s_add_u32 m0, s63, 64512
    s_nop 0
    buffer_load_dwordx4 v19, s[40:43], s50 offen  lds
    s_add_u32 m0, s63, 65536
    s_nop 0
    buffer_load_dwordx4 v20, s[40:43], s50 offen  lds
    s_add_u32 s64, s62, 2
    s_and_b32 s64, s64, 3
    s_lshl_b32 s65, s64, 13
    s_add_u32 s50, s65, 128
    s_add_u32 m0, s67, 32768
    s_nop 0
    buffer_load_dwordx4 v14, s[28:31], s50 offen  lds
    s_add_u32 s50, s65, 2176
    s_add_u32 m0, s67, 33792
    s_nop 0
    buffer_load_dwordx4 v15, s[28:31], s50 offen  lds
    s_add_u32 s50, s65, 4224
    s_add_u32 m0, s67, 34816
    s_nop 0
    buffer_load_dwordx4 v14, s[28:31], s50 offen  lds
    s_add_u32 s50, s65, 6272
    s_add_u32 m0, s67, 35840
    s_nop 0
    buffer_load_dwordx4 v15, s[28:31], s50 offen  lds
    s_waitcnt vmcnt(12)
    s_barrier
    s_add_u32 s64, s62, 3
    s_and_b32 s64, s64, 3
    s_mul_i32 s66, s64, 147456
    s_add_u32 s50, s66, 0
    s_add_u32 m0, s63, 0
    s_nop 0
    buffer_load_dwordx4 v16, s[40:43], s50 offen  lds
    s_add_u32 m0, s63, 1024
    s_nop 0
    buffer_load_dwordx4 v17, s[40:43], s50 offen  lds
    s_add_u32 m0, s63, 2048
    s_nop 0
    buffer_load_dwordx4 v18, s[40:43], s50 offen  lds
    s_add_u32 m0, s63, 3072
    s_nop 0
    buffer_load_dwordx4 v19, s[40:43], s50 offen  lds
    s_add_u32 m0, s63, 4096
    s_nop 0
    buffer_load_dwordx4 v20, s[40:43], s50 offen  lds
    s_add_u32 s64, s62, 3
    s_and_b32 s64, s64, 3
    s_lshl_b32 s65, s64, 13
    s_add_u32 s50, s65, 0
    s_add_u32 m0, s67, 0
    s_nop 0
    buffer_load_dwordx4 v14, s[28:31], s50 offen  lds
    s_add_u32 s50, s65, 2048
    s_add_u32 m0, s67, 1024
    s_nop 0
    buffer_load_dwordx4 v15, s[28:31], s50 offen  lds
    s_add_u32 s50, s65, 4096
    s_add_u32 m0, s67, 2048
    s_nop 0
    buffer_load_dwordx4 v14, s[28:31], s50 offen  lds
    s_add_u32 s50, s65, 6144
    s_add_u32 m0, s67, 3072
    s_nop 0
    buffer_load_dwordx4 v15, s[28:31], s50 offen  lds
    s_waitcnt vmcnt(9)
    s_barrier
    s_add_u32 s64, s62, 3
    s_and_b32 s64, s64, 3
    s_mul_i32 s66, s64, 147456
    s_add_u32 s50, s66, 73728
    s_add_u32 m0, s63, 20480
    s_nop 0
    buffer_load_dwordx4 v16, s[40:43], s50 offen  lds
    s_add_u32 m0, s63, 21504
    s_nop 0
    buffer_load_dwordx4 v17, s[40:43], s50 offen  lds
    s_add_u32 m0, s63, 22528
    s_nop 0
    buffer_load_dwordx4 v18, s[40:43], s50 offen  lds
    s_add_u32 m0, s63, 23552
    s_nop 0
    buffer_load_dwordx4 v19, s[40:43], s50 offen  lds
    s_add_u32 m0, s63, 24576
    s_nop 0
    buffer_load_dwordx4 v20, s[40:43], s50 offen  lds
    s_add_u32 s64, s62, 3
    s_and_b32 s64, s64, 3
    s_lshl_b32 s65, s64, 13
    s_add_u32 s50, s65, 128
    s_add_u32 m0, s67, 16384
    s_nop 0
    buffer_load_dwordx4 v14, s[28:31], s50 offen  lds
    s_add_u32 s50, s65, 2176
    s_add_u32 m0, s67, 17408
    s_nop 0
    buffer_load_dwordx4 v15, s[28:31], s50 offen  lds
    s_add_u32 s50, s65, 4224
    s_add_u32 m0, s67, 18432
    s_nop 0
    buffer_load_dwordx4 v14, s[28:31], s50 offen  lds
    s_add_u32 s50, s65, 6272
    s_add_u32 m0, s67, 19456
    s_nop 0
    buffer_load_dwordx4 v15, s[28:31], s50 offen  lds
    s_waitcnt vmcnt(9)
    s_barrier
    s_lshl_b32 s58, s46, 5
    s_lshl_b32 s59, s13, 2
    s_add_u32 s58, s58, s59
    s_lshl_b32 s58, s58, 6
    s_add_u32 s58, s58, 264503296
    v_bfe_u32 v77, v2, 4, 1
    v_add_u32 v77, 1, v77
    v_add_u32 v77, s19, v77
    v_and_b32 v77, 3, v77
    v_lshlrev_b32 v77, 6, v77
    v_bfe_u32 v78, v2, 5, 1
    v_lshlrev_b32 v78, 2, v78
    v_add_u32 v77, v77, v78
    v_add_u32 v77, s58, v77
    s_add_u32 s59, s19, 3
    s_and_b32 s59, s59, 3
    s_lshl_b32 s59, s59, 6
    s_add_u32 s59, s59, s58
    v_add_u32 v78, s59, v78
L_pretry_49:
    s_add_u32 s58, s19, 1
    s_and_b32 s58, s58, 3
    s_lshl_b32 s58, s58, 11
    s_add_u32 s59, s58, s49
    s_add_u32 s50, s58, 0
    s_add_u32 m0, s59, 131072
    s_nop 0
    buffer_load_dwordx4 v21, s[36:39], s50 offen sc1 lds
    s_add_u32 s50, s58, 1024
    s_add_u32 m0, s59, 132096
    s_nop 0
    buffer_load_dwordx4 v21, s[36:39], s50 offen sc1 lds
    s_add_u32 s58, s19, 2
    s_and_b32 s58, s58, 3
    s_lshl_b32 s58, s58, 11
    s_add_u32 s59, s58, s49
    s_add_u32 s50, s58, 0
    s_add_u32 m0, s59, 131072
    s_nop 0
    buffer_load_dwordx4 v21, s[36:39], s50 offen sc1 lds
    s_add_u32 s50, s58, 1024
    s_add_u32 m0, s59, 132096
    s_nop 0
    buffer_load_dwordx4 v21, s[36:39], s50 offen sc1 lds
    s_add_u32 s58, s19, 3
    s_and_b32 s58, s58, 3
    s_lshl_b32 s58, s58, 11
    s_add_u32 s59, s58, s49
    s_add_u32 s50, s58, 0
    s_add_u32 m0, s59, 131072
    s_nop 0
    buffer_load_dwordx4 v21, s[36:39], s50 offen sc1 lds
    s_add_u32 s50, s58, 1024
    s_add_u32 m0, s59, 132096
    s_nop 0
    buffer_load_dwordx4 v21, s[36:39], s50 offen sc1 lds
    buffer_load_dword v79, v77, s[36:39], 0 offen sc1
    buffer_load_dword v80, v78, s[36:39], 0 offen sc1
    s_waitcnt vmcnt(8)
    s_barrier
    s_waitcnt vmcnt(0)
    v_lshlrev_b32 v81, 4, v2
    s_add_u32 s58, s49, 131072
    v_add_u32 v81, s58, v81
L_pval_50:
    s_add_u32 s58, s19, 1
    s_and_b32 s58, s58, 3
    s_lshl_b32 s58, s58, 11
    v_add_u32 v82, s58, v81
    ds_read_b128 v[84:87], v82 offset:0
    ds_read_b128 v[88:91], v82 offset:1024
    s_add_u32 s58, s19, 2
    s_and_b32 s58, s58, 3
    s_lshl_b32 s58, s58, 11
    v_add_u32 v82, s58, v81
    ds_read_b128 v[92:95], v82 offset:0
    ds_read_b128 v[96:99], v82 offset:1024
    s_add_u32 s58, s19, 3
    s_and_b32 s58, s58, 3
    s_lshl_b32 s58, s58, 11
    v_add_u32 v82, s58, v81
    ds_read_b128 v[100:103], v82 offset:0
    ds_read_b128 v[104:107], v82 offset:1024
    s_waitcnt lgkmcnt(0)
    v_alignbit_b32 v114, v85, v85, 25
    v_alignbit_b32 v115, v86, v86, 19
    v_add3_u32 v108, v84, v114, v115
    v_alignbit_b32 v114, v87, v87, 9
    v_add_u32 v108, v108, v114
    v_mul_lo_u32 v108, v108, v71
    v_lshrrev_b32 v114, 16, v108
    v_xor_b32 v108, v108, v114
    v_alignbit_b32 v114, v89, v89, 25
    v_alignbit_b32 v115, v90, v90, 19
    v_add3_u32 v109, v88, v114, v115
    v_alignbit_b32 v114, v91, v91, 9
    v_add_u32 v109, v109, v114
    v_mul_lo_u32 v109, v109, v71
    v_lshrrev_b32 v114, 16, v109
    v_xor_b32 v109, v109, v114
    v_alignbit_b32 v114, v93, v93, 25
    v_alignbit_b32 v115, v94, v94, 19
    v_add3_u32 v110, v92, v114, v115
    v_alignbit_b32 v114, v95, v95, 9
    v_add_u32 v110, v110, v114
    v_mul_lo_u32 v110, v110, v71
    v_lshrrev_b32 v114, 16, v110
    v_xor_b32 v110, v110, v114
    v_alignbit_b32 v114, v97, v97, 25
    v_alignbit_b32 v115, v98, v98, 19
    v_add3_u32 v111, v96, v114, v115
    v_alignbit_b32 v114, v99, v99, 9
    v_add_u32 v111, v111, v114
    v_mul_lo_u32 v111, v111, v71
    v_lshrrev_b32 v114, 16, v111
    v_xor_b32 v111, v111, v114
    v_alignbit_b32 v114, v101, v101, 25
    v_alignbit_b32 v115, v102, v102, 19
    v_add3_u32 v112, v100, v114, v115
    v_alignbit_b32 v114, v103, v103, 9
    v_add_u32 v112, v112, v114
    v_mul_lo_u32 v112, v112, v71
    v_lshrrev_b32 v114, 16, v112
    v_xor_b32 v112, v112, v114
    v_alignbit_b32 v114, v105, v105, 25
    v_alignbit_b32 v115, v106, v106, 19
    v_add3_u32 v113, v104, v114, v115
    v_alignbit_b32 v114, v107, v107, 9
    v_add_u32 v113, v113, v114
    v_mul_lo_u32 v113, v113, v71
    v_lshrrev_b32 v114, 16, v113
    v_xor_b32 v113, v113, v114
    v_mov_b32 v114, 0
    v_mov_b32 v115, 0
    s_nop 1
    v_permlane32_swap_b32 v108, v109
    v_permlane32_swap_b32 v110, v111
    s_nop 1
    v_xor_b32 v108, v108, v109
    v_xor_b32 v110, v110, v111
    s_nop 1
    v_permlane16_swap_b32 v108, v110
    s_nop 1
    v_xor_b32 v108, v108, v110
    s_nop 1
    v_xor_b32_dpp v108, v108, v108 row_ror:8 row_mask:0xf bank_mask:0xf
    s_nop 1
    v_xor_b32_dpp v108, v108, v108 row_ror:4 row_mask:0xf bank_mask:0xf
    s_nop 1
    v_xor_b32_dpp v108, v108, v108 row_ror:2 row_mask:0xf bank_mask:0xf
    s_nop 1
    v_xor_b32_dpp v108, v108, v108 row_ror:1 row_mask:0xf bank_mask:0xf
    s_nop 1
    v_permlane32_swap_b32 v112, v113
    v_permlane32_swap_b32 v114, v115
    s_nop 1
    v_xor_b32 v112, v112, v113
    v_xor_b32 v114, v114, v115
    s_nop 1
    v_permlane16_swap_b32 v112, v114
    s_nop 1
    v_xor_b32 v112, v112, v114
    s_nop 1
    v_xor_b32_dpp v112, v112, v112 row_ror:8 row_mask:0xf bank_mask:0xf
    s_nop 1
    v_xor_b32_dpp v112, v112, v112 row_ror:4 row_mask:0xf bank_mask:0xf
    s_nop 1
    v_xor_b32_dpp v112, v112, v112 row_ror:2 row_mask:0xf bank_mask:0xf
    s_nop 1
    v_xor_b32_dpp v112, v112, v112 row_ror:1 row_mask:0xf bank_mask:0xf
    v_xor_b32 v108, s74, v108
    v_xor_b32 v112, s74, v112
    v_cmp_ne_u32 s[58:59], v108, v79
    v_cmp_ne_u32 vcc, v112, v80
    s_nop 3
    s_and_b32 vcc_lo, vcc_lo, 0x0000ffff
    s_and_b32 vcc_hi, vcc_hi, 0x0000ffff
    s_or_b64 s[58:59], s[58:59], vcc
    s_cmp_eq_u64 s[58:59], 0
    s_cbranch_scc1 L_pok_51
    s_add_u32 s58, s19, 1
    s_and_b32 s58, s58, 3
    s_lshl_b32 s58, s58, 11
    s_add_u32 s59, s58, s49
    s_add_u32 s50, s58, 0
    s_add_u32 m0, s59, 131072
    s_nop 0
    buffer_load_dwordx4 v21, s[36:39], s50 offen sc1 lds
    s_add_u32 s50, s58, 1024
    s_add_u32 m0, s59, 132096
    s_nop 0
    buffer_load_dwordx4 v21, s[36:39], s50 offen sc1 lds
    s_add_u32 s58, s19, 2
    s_and_b32 s58, s58, 3
    s_lshl_b32 s58, s58, 11
    s_add_u32 s59, s58, s49
    s_add_u32 s50, s58, 0
    s_add_u32 m0, s59, 131072
    s_nop 0
    buffer_load_dwordx4 v21, s[36:39], s50 offen sc1 lds
    s_add_u32 s50, s58, 1024
    s_add_u32 m0, s59, 132096
    s_nop 0
    buffer_load_dwordx4 v21, s[36:39], s50 offen sc1 lds
    s_add_u32 s58, s19, 3
    s_and_b32 s58, s58, 3
    s_lshl_b32 s58, s58, 11
    s_add_u32 s59, s58, s49
    s_add_u32 s50, s58, 0
    s_add_u32 m0, s59, 131072
    s_nop 0
    buffer_load_dwordx4 v21, s[36:39], s50 offen sc1 lds
    s_add_u32 s50, s58, 1024
    s_add_u32 m0, s59, 132096
    s_nop 0
    buffer_load_dwordx4 v21, s[36:39], s50 offen sc1 lds
    buffer_load_dword v79, v77, s[36:39], 0 offen sc1
    buffer_load_dword v80, v78, s[36:39], 0 offen sc1
    s_waitcnt vmcnt(0)
    s_branch L_pval_50
L_pok_51:
    s_barrier
    s_mov_b32 s21, 4
    s_lshr_b32 s22, s13, 1
    s_lshl_b32 s23, s18, 2
    s_add_u32 s23, s23, s19
    s_lshl_b32 s23, s23, 2
    s_add_u32 s23, s23, s22
    s_mul_i32 s20, s23, 9
    s_add_u32 s20, s20, s21
    s_lshl_b32 s58, s20, 13
    s_add_u32 s58, s58, 253755392
    v_lshlrev_b32 v3, 4, v2
    v_add_u32 v3, s58, v3
    s_lshl_b32 s58, s23, 9
    s_lshl_b32 s59, s21, 2
    s_add_u32 s58, s58, s59
    s_add_u32 s58, s58, 264765440
    v_bfe_u32 v6, v2, 4, 1
    v_lshlrev_b32 v6, 7, v6
    v_bfe_u32 v7, v2, 5, 1
    v_lshlrev_b32 v7, 6, v7
    v_add_u32 v6, v6, v7
    v_add_u32 v6, s58, v6
    v_lshlrev_b32 v108, 1, v2
    v_or_b32 v108, 1, v108
    s_mov_b32 s61, 0x9E3779B1
    v_mul_lo_u32 v108, v108, s61
    s_lshl_b32 s58, s21, 10
    v_lshlrev_b32 v7, 4, v2
    v_add_u32 v7, s58, v7
    s_load_dwordx2 s[6:7], s[0:1], 40
    s_lshl_b32 s59, s18, 7
    s_lshl_b32 s61, s22, 5
    s_add_u32 s59, s59, s61
    s_mul_i32 s59, s59, 1152
    s_mul_i32 s63, s19, 288
    s_lshl_b32 s60, s21, 5
    s_add_u32 s59, s59, s63
    s_add_u32 s59, s59, s60
    v_and_b32 v4, 15, v2
    s_movk_i32 s45, 1152
    v_mul_lo_u32 v4, v4, s45
    v_lshrrev_b32 v5, 4, v2
    v_lshlrev_b32 v5, 3, v5
    v_add_u32 v4, v4, v5
    v_add_u32 v4, s59, v4
    s_barrier
    s_and_b32 s58, s13, 1
    s_or_b32 s58, s58, s12
    s_cmp_lg_u32 s58, 0
    s_cbranch_scc1 L_notask_52
L_retry_54:
    s_cmp_eq_u32 s13, 0
    s_cbranch_scc1 L_rown_56
    s_mov_b32 s50, 0
    buffer_load_dwordx4 v[64:67], v3, s[36:39], s50 offen sc1
    s_branch L_rownc_57
L_rown_56:
    ds_read_b128 v[64:67], v7
L_rownc_57:
    s_cmp_eq_u32 s13, 1
    s_cbranch_scc1 L_rown_58
    s_mov_b32 s50, 1024
    buffer_load_dwordx4 v[68:71], v3, s[36:39], s50 offen sc1
    s_branch L_rownc_59
L_rown_58:
    ds_read_b128 v[68:71], v7
L_rownc_59:
    s_cmp_eq_u32 s13, 2
    s_cbranch_scc1 L_rown_60
    s_mov_b32 s50, 2048
    buffer_load_dwordx4 v[72:75], v3, s[36:39], s50 offen sc1
    s_branch L_rownc_61
L_rown_60:
    ds_read_b128 v[72:75], v7
L_rownc_61:
    s_cmp_eq_u32 s13, 3
    s_cbranch_scc1 L_rown_62
    s_mov_b32 s50, 3072
    buffer_load_dwordx4 v[76:79], v3, s[36:39], s50 offen sc1
    s_branch L_rownc_63
L_rown_62:
    ds_read_b128 v[76:79], v7
L_rownc_63:
    s_cmp_eq_u32 s13, 4
    s_cbranch_scc1 L_rown_64
    s_mov_b32 s50, 4096
    buffer_load_dwordx4 v[80:83], v3, s[36:39], s50 offen sc1
    s_branch L_rownc_65
L_rown_64:
    ds_read_b128 v[80:83], v7
L_rownc_65:
    s_cmp_eq_u32 s13, 5
    s_cbranch_scc1 L_rown_66
    s_mov_b32 s50, 5120
    buffer_load_dwordx4 v[84:87], v3, s[36:39], s50 offen sc1
    s_branch L_rownc_67
L_rown_66:
    ds_read_b128 v[84:87], v7
L_rownc_67:
    s_cmp_eq_u32 s13, 6
    s_cbranch_scc1 L_rown_68
    s_mov_b32 s50, 6144
    buffer_load_dwordx4 v[88:91], v3, s[36:39], s50 offen sc1
    s_branch L_rownc_69
L_rown_68:
    ds_read_b128 v[88:91], v7
L_rownc_69:
    s_cmp_eq_u32 s13, 7
    s_cbranch_scc1 L_rown_70
    s_mov_b32 s50, 7168
    buffer_load_dwordx4 v[92:95], v3, s[36:39], s50 offen sc1
    s_branch L_rownc_71
L_rown_70:
    ds_read_b128 v[92:95], v7
L_rownc_71:
    buffer_load_dword v18, v6, s[36:39], 0 offen sc1
    buffer_load_dword v19, v6, s[36:39], 0 offen offset:256 sc1
    s_waitcnt lgkmcnt(0)
    s_waitcnt vmcnt(8)
    v_alignbit_b32 v109, v65, v65, 25
    v_alignbit_b32 v110, v66, v66, 19
    v_add3_u32 v100, v64, v109, v110
    v_alignbit_b32 v109, v67, v67, 9
    v_add_u32 v100, v100, v109
    v_mul_lo_u32 v100, v100, v108
    v_lshrrev_b32 v109, 16, v100
    v_xor_b32 v100, v100, v109
    v_lshlrev_b32 v8, 16, v64
    v_and_b32 v9, 0xffff0000, v64
    v_lshlrev_b32 v10, 16, v65
    v_and_b32 v11, 0xffff0000, v65
    v_lshlrev_b32 v12, 16, v66
    v_and_b32 v13, 0xffff0000, v66
    v_lshlrev_b32 v14, 16, v67
    v_and_b32 v15, 0xffff0000, v67
    s_waitcnt vmcnt(7)
    v_alignbit_b32 v109, v69, v69, 25
    v_alignbit_b32 v110, v70, v70, 19
    v_add3_u32 v101, v68, v109, v110
    v_alignbit_b32 v109, v71, v71, 9
    v_add_u32 v101, v101, v109
    v_mul_lo_u32 v101, v101, v108
    v_lshrrev_b32 v109, 16, v101
    v_xor_b32 v101, v101, v109
    v_lshlrev_b32 v16, 16, v68
    v_and_b32 v17, 0xffff0000, v68
    v_add_f32 v8, v8, v16
    v_add_f32 v9, v9, v17
    v_lshlrev_b32 v16, 16, v69
    v_and_b32 v17, 0xffff0000, v69
    v_add_f32 v10, v10, v16
    v_add_f32 v11, v11, v17
    v_lshlrev_b32 v16, 16, v70
    v_and_b32 v17, 0xffff0000, v70
    v_add_f32 v12, v12, v16
    v_add_f32 v13, v13, v17
    v_lshlrev_b32 v16, 16, v71
    v_and_b32 v17, 0xffff0000, v71
    v_add_f32 v14, v14, v16
    v_add_f32 v15, v15, v17
    s_waitcnt vmcnt(6)
    v_alignbit_b32 v109, v73, v73, 25
    v_alignbit_b32 v110, v74, v74, 19
    v_add3_u32 v102, v72, v109, v110
    v_alignbit_b32 v109, v75, v75, 9
    v_add_u32 v102, v102, v109
    v_mul_lo_u32 v102, v102, v108
    v_lshrrev_b32 v109, 16, v102
    v_xor_b32 v102, v102, v109
    v_lshlrev_b32 v16, 16, v72
    v_and_b32 v17, 0xffff0000, v72
    v_add_f32 v8, v8, v16
    v_add_f32 v9, v9, v17
    v_lshlrev_b32 v16, 16, v73
    v_and_b32 v17, 0xffff0000, v73
    v_add_f32 v10, v10, v16
    v_add_f32 v11, v11, v17
    v_lshlrev_b32 v16, 16, v74
    v_and_b32 v17, 0xffff0000, v74
    v_add_f32 v12, v12, v16
    v_add_f32 v13, v13, v17
    v_lshlrev_b32 v16, 16, v75
    v_and_b32 v17, 0xffff0000, v75
    v_add_f32 v14, v14, v16
    v_add_f32 v15, v15, v17
    s_waitcnt vmcnt(5)
    v_alignbit_b32 v109, v77, v77, 25
    v_alignbit_b32 v110, v78, v78, 19
    v_add3_u32 v103, v76, v109, v110
    v_alignbit_b32 v109, v79, v79, 9
    v_add_u32 v103, v103, v109
    v_mul_lo_u32 v103, v103, v108
    v_lshrrev_b32 v109, 16, v103
    v_xor_b32 v103, v103, v109
    v_lshlrev_b32 v16, 16, v76
    v_and_b32 v17, 0xffff0000, v76
    v_add_f32 v8, v8, v16
    v_add_f32 v9, v9, v17
    v_lshlrev_b32 v16, 16, v77
    v_and_b32 v17, 0xffff0000, v77
    v_add_f32 v10, v10, v16
    v_add_f32 v11, v11, v17
    v_lshlrev_b32 v16, 16, v78
    v_and_b32 v17, 0xffff0000, v78
    v_add_f32 v12, v12, v16
    v_add_f32 v13, v13, v17
    v_lshlrev_b32 v16, 16, v79
    v_and_b32 v17, 0xffff0000, v79
    v_add_f32 v14, v14, v16
    v_add_f32 v15, v15, v17
    s_waitcnt vmcnt(4)
    v_alignbit_b32 v109, v81, v81, 25
    v_alignbit_b32 v110, v82, v82, 19
    v_add3_u32 v104, v80, v109, v110
    v_alignbit_b32 v109, v83, v83, 9
    v_add_u32 v104, v104, v109
    v_mul_lo_u32 v104, v104, v108
    v_lshrrev_b32 v109, 16, v104
    v_xor_b32 v104, v104, v109
    v_lshlrev_b32 v16, 16, v80
    v_and_b32 v17, 0xffff0000, v80
    v_add_f32 v8, v8, v16
    v_add_f32 v9, v9, v17
    v_lshlrev_b32 v16, 16, v81
    v_and_b32 v17, 0xffff0000, v81
    v_add_f32 v10, v10, v16
    v_add_f32 v11, v11, v17
    v_lshlrev_b32 v16, 16, v82
    v_and_b32 v17, 0xffff0000, v82
    v_add_f32 v12, v12, v16
    v_add_f32 v13, v13, v17
    v_lshlrev_b32 v16, 16, v83
    v_and_b32 v17, 0xffff0000, v83
    v_add_f32 v14, v14, v16
    v_add_f32 v15, v15, v17
    s_waitcnt vmcnt(3)
    v_alignbit_b32 v109, v85, v85, 25
    v_alignbit_b32 v110, v86, v86, 19
    v_add3_u32 v105, v84, v109, v110
    v_alignbit_b32 v109, v87, v87, 9
    v_add_u32 v105, v105, v109
    v_mul_lo_u32 v105, v105, v108
    v_lshrrev_b32 v109, 16, v105
    v_xor_b32 v105, v105, v109
    v_lshlrev_b32 v16, 16, v84
    v_and_b32 v17, 0xffff0000, v84
    v_add_f32 v8, v8, v16
    v_add_f32 v9, v9, v17
    v_lshlrev_b32 v16, 16, v85
    v_and_b32 v17, 0xffff0000, v85
    v_add_f32 v10, v10, v16
    v_add_f32 v11, v11, v17
    v_lshlrev_b32 v16, 16, v86
    v_and_b32 v17, 0xffff0000, v86
    v_add_f32 v12, v12, v16
    v_add_f32 v13, v13, v17
    v_lshlrev_b32 v16, 16, v87
    v_and_b32 v17, 0xffff0000, v87
    v_add_f32 v14, v14, v16
    v_add_f32 v15, v15, v17
    s_waitcnt vmcnt(2)
    v_alignbit_b32 v109, v89, v89, 25
    v_alignbit_b32 v110, v90, v90, 19
    v_add3_u32 v106, v88, v109, v110
    v_alignbit_b32 v109, v91, v91, 9
    v_add_u32 v106, v106, v109
    v_mul_lo_u32 v106, v106, v108
    v_lshrrev_b32 v109, 16, v106
    v_xor_b32 v106, v106, v109
    v_lshlrev_b32 v16, 16, v88
    v_and_b32 v17, 0xffff0000, v88
    v_add_f32 v8, v8, v16
    v_add_f32 v9, v9, v17
    v_lshlrev_b32 v16, 16, v89
    v_and_b32 v17, 0xffff0000, v89
    v_add_f32 v10, v10, v16
    v_add_f32 v11, v11, v17
    v_lshlrev_b32 v16, 16, v90
    v_and_b32 v17, 0xffff0000, v90
    v_add_f32 v12, v12, v16
    v_add_f32 v13, v13, v17
    v_lshlrev_b32 v16, 16, v91
    v_and_b32 v17, 0xffff0000, v91
    v_add_f32 v14, v14, v16
    v_add_f32 v15, v15, v17
    s_waitcnt vmcnt(2)
    v_alignbit_b32 v109, v93, v93, 25
    v_alignbit_b32 v110, v94, v94, 19
    v_add3_u32 v107, v92, v109, v110
    v_alignbit_b32 v109, v95, v95, 9
    v_add_u32 v107, v107, v109
    v_mul_lo_u32 v107, v107, v108
    v_lshrrev_b32 v109, 16, v107
    v_xor_b32 v107, v107, v109
    v_lshlrev_b32 v16, 16, v92
    v_and_b32 v17, 0xffff0000, v92
    v_add_f32 v8, v8, v16
    v_add_f32 v9, v9, v17
    v_lshlrev_b32 v16, 16, v93
    v_and_b32 v17, 0xffff0000, v93
    v_add_f32 v10, v10, v16
    v_add_f32 v11, v11, v17
    v_lshlrev_b32 v16, 16, v94
    v_and_b32 v17, 0xffff0000, v94
    v_add_f32 v12, v12, v16
    v_add_f32 v13, v13, v17
    v_lshlrev_b32 v16, 16, v95
    v_and_b32 v17, 0xffff0000, v95
    v_add_f32 v14, v14, v16
    v_add_f32 v15, v15, v17
    s_nop 1
    v_permlane32_swap_b32 v100, v101
    v_permlane32_swap_b32 v102, v103
    v_permlane32_swap_b32 v104, v105
    v_permlane32_swap_b32 v106, v107
    s_nop 1
    v_xor_b32 v100, v100, v101
    v_xor_b32 v102, v102, v103
    v_xor_b32 v104, v104, v105
    v_xor_b32 v106, v106, v107
    s_nop 1
    v_permlane16_swap_b32 v100, v102
    v_permlane16_swap_b32 v104, v106
    s_nop 1
    v_xor_b32 v100, v100, v102
    v_xor_b32 v104, v104, v106
    s_nop 1
    v_xor_b32_dpp v100, v100, v100 row_ror:8 row_mask:0xf bank_mask:0xf
    v_xor_b32_dpp v104, v104, v104 row_ror:8 row_mask:0xf bank_mask:0xf
    s_nop 1
    v_xor_b32_dpp v100, v100, v100 row_ror:4 row_mask:0xf bank_mask:0xf
    v_xor_b32_dpp v104, v104, v104 row_ror:4 row_mask:0xf bank_mask:0xf
    s_nop 1
    v_xor_b32_dpp v100, v100, v100 row_ror:2 row_mask:0xf bank_mask:0xf
    v_xor_b32_dpp v104, v104, v104 row_ror:2 row_mask:0xf bank_mask:0xf
    s_nop 1
    v_xor_b32_dpp v100, v100, v100 row_ror:1 row_mask:0xf bank_mask:0xf
    v_xor_b32_dpp v104, v104, v104 row_ror:1 row_mask:0xf bank_mask:0xf
    s_waitcnt vmcnt(0) lgkmcnt(0)
    v_xor_b32 v100, s74, v100
    v_xor_b32 v104, s74, v104
    v_xor_b32 v100, v100, v18
    v_xor_b32 v104, v104, v19
    v_or_b32 v100, v100, v104
    v_cmp_ne_u32 vcc, 0, v100
    s_cbranch_vccnz L_retry_54
    s_mov_b32 s24, s6
    s_and_b32 s25, s7, 0xffff
    s_mov_b32 s26, 0x120000
    s_mov_b32 s27, 0x00020000
    v_cvt_pk_bf16_f32 v20, v8, v9
    v_cvt_pk_bf16_f32 v21, v10, v11
    v_cvt_pk_bf16_f32 v22, v12, v13
    v_cvt_pk_bf16_f32 v23, v14, v15
    s_mov_b32 s50, 18432
    buffer_store_dwordx2 v[20:21], v4, s[24:27], 0 offen
    buffer_store_dwordx2 v[22:23], v4, s[24:27], s50 offen
L_notask_52:
L_fin_3:
L_end_1:
    s_endpgm
L_code_end:
.section .rodata,"a"
.p2align 6
.amdhsa_kernel standalone__mha_block_cached__near_ridge_kernel
.amdhsa_next_free_vgpr 256
.amdhsa_next_free_sgpr 102
.amdhsa_accum_offset 256
.amdhsa_group_segment_fixed_size 0
.amdhsa_kernarg_size 64
.amdhsa_user_sgpr_count 2
.amdhsa_user_sgpr_kernarg_segment_ptr 1
.amdhsa_system_sgpr_workgroup_id_x 1
.end_amdhsa_kernel
```
